```python
import torch

def _softmax(x, axis=-1):
    return torch.softmax(x, dim=axis)
def _gelu(x):
    return torch.nn.functional.gelu(x, approximate="tanh")
def _silu(x):
    return torch.nn.functional.silu(x)
def _sigmoid(x):
    return torch.sigmoid(x)
def _layernorm(x, axis=-1, eps=1e-5):
    m = x.mean(dim=axis, keepdim=True)
    v = x.var(dim=axis, keepdim=True, unbiased=False)
    return (x - m) / torch.sqrt(v + eps)
def _scatter_add(tgt, idx, src, axis=0):
    return tgt.clone().index_add_(axis, idx, src)
def _segment_sum(src, seg, n):
    out = torch.zeros((n,) + src.shape[1:], dtype=src.dtype)
    return out.index_add_(0, seg, src)
def _pad(x, pw):
    flat = tuple(v for pair in reversed(pw) for v in pair)
    return torch.nn.functional.pad(x, flat)

kernel_name = 'parallel_sum__ssm_conv_s5__glu_gated_swiglu__prompt'

def setup_inputs():

    _w = (lambda a: (lambda t: t.to(torch.bfloat16) if t.is_floating_point() else t)(torch.as_tensor(a)))
    def _A_setup():
        B, S, D = 1, 2048, 512
        P = D
        Lambda_re = -0.5 * (lambda _x: torch.exp(torch.as_tensor(_x)))((lambda *s: torch.randn(*s, dtype=torch.bfloat16) * 0.2)(P))
        Lambda_im = (lambda *s: torch.randn(*s, dtype=torch.bfloat16) * 0.8)(P) * 1.0
        B_re = (lambda *s: torch.randn(*s, dtype=torch.bfloat16) * 0.2)(P, D) * (D ** -0.5)
        B_im = (lambda *s: torch.randn(*s, dtype=torch.bfloat16) * 0.2)(P, D) * (D ** -0.5)
        C_re = (lambda *s: torch.randn(*s, dtype=torch.bfloat16) * 0.2)(D, P) * (P ** -0.5)
        C_im = (lambda *s: torch.randn(*s, dtype=torch.bfloat16) * 0.2)(D, P) * (P ** -0.5)
        log_dt = (lambda *s: torch.randn(*s, dtype=torch.bfloat16) * 0.2)(P) * 0.3 - 2.0
        Dskip = (lambda *s: torch.randn(*s, dtype=torch.bfloat16) * 0.05)(D)
        return {
            "x": _w((lambda *s: torch.randn(*s, dtype=torch.bfloat16) * 0.05)(B, S, D)),
            "Lambda_re": _w(Lambda_re),
            "Lambda_im": _w(Lambda_im),
            "B_re": _w(B_re),
            "B_im": _w(B_im),
            "C_re": _w(C_re),
            "C_im": _w(C_im),
            "log_dt": _w(log_dt),
            "Dskip": _w(Dskip),
        }
    _A_in = _A_setup()

    def _B_setup():
        B, S, D, F = 1, 2048, 512, 1792
        return {
            "x": _w((lambda *s: torch.randn(*s, dtype=torch.bfloat16) * 0.05)(B, S, D)),
            "w1": _w((lambda *s: torch.randn(*s, dtype=torch.bfloat16) * 0.4)(D, F) * (2.0 / D) ** 0.5),
            "w3": _w((lambda *s: torch.randn(*s, dtype=torch.bfloat16) * 0.4)(D, F) * (2.0 / D) ** 0.5),
            "w2": _w((lambda *s: torch.randn(*s, dtype=torch.bfloat16) * 0.4)(F, D) * (2.0 / F) ** 0.5),
        }
    _B_in = _B_setup()

    return {
        "A_x": _A_in["x"],
        "A_Lambda_re": _A_in["Lambda_re"],
        "A_Lambda_im": _A_in["Lambda_im"],
        "A_B_re": _A_in["B_re"],
        "A_B_im": _A_in["B_im"],
        "A_C_re": _A_in["C_re"],
        "A_C_im": _A_in["C_im"],
        "A_log_dt": _A_in["log_dt"],
        "A_Dskip": _A_in["Dskip"],
        "B_x": _B_in["x"],
        "B_w1": _B_in["w1"],
        "B_w3": _B_in["w3"],
        "B_w2": _B_in["w2"],
    }

def reference(A_x, A_Lambda_re, A_Lambda_im, A_B_re, A_B_im, A_C_re, A_C_im, A_log_dt, A_Dskip, B_x, B_w1, B_w3, B_w2):
    def _A_ref(x, Lambda_re, Lambda_im, B_re, B_im, C_re, C_im, log_dt, Dskip):
        Bsz, L, H = x.shape
        Lam = Lambda_re + 1j * Lambda_im
        Bmat = B_re + 1j * B_im
        Cmat = C_re + 1j * C_im
        dt = torch.exp(log_dt)
        Lam_bar = torch.exp(dt * Lam)
        B_bar = ((Lam_bar - 1.0) / Lam)[:, None] * Bmat
        Bu = torch.einsum("bld,pd->blp", x + 0j, B_bar)
        h = torch.zeros_like(Bu[:, 0, :])
        hs = []
        for t in range(L):
            h = Lam_bar[None, :] * h + Bu[:, t, :]
            hs.append(h)
        hseq = torch.stack(hs, 1)
        y = 2.0 * torch.einsum("blp,dp->bld", hseq, Cmat).real + x * Dskip[None, None, :]
        return y

    def _B_ref(x, w1, w3, w2):
        gate = torch.einsum("bsd,df->bsf", x, w1)
        up = torch.einsum("bsd,df->bsf", x, w3)
        h = _silu(gate) * up
        out = torch.einsum("bsf,fd->bsd", h, w2)
        return out

    x = A_x
    xn = _layernorm(x, axis=-1)
    return x + _A_ref(xn, A_Lambda_re, A_Lambda_im, A_B_re, A_B_im, A_C_re, A_C_im, A_log_dt, A_Dskip) + _B_ref(xn, B_w1, B_w3, B_w2)
```

```asm
; @launch kernel=phase_b_kernel grid=(256,1,1) block=(512,1,1) lds=163840
.amdgcn_target "amdgcn-amd-amdhsa--gfx950"
.text
.globl phase_b_kernel
.p2align 8
.type phase_b_kernel,@function
phase_b_kernel:
  s_cmp_ge_u32 s2, 256
  s_cbranch_scc1 LB_done
  s_load_dwordx16 s[64:79], s[0:1], 0
  s_load_dwordx16 s[80:95], s[0:1], 64
  s_memrealtime s[96:97]
  s_memrealtime s[100:101]
  v_lshrrev_b32 v1, 6, v0
  v_and_b32 v0, 63, v0
  s_and_b32 s3, s2, 7
  s_lshr_b32 s4, s2, 3
  v_readfirstlane_b32 s44, v1
  s_and_b32 s46, s3, 1
  s_lshl_b32 s46, s46, 3
  s_and_b32 s5, s4, 7
  s_add_u32 s46, s46, s5
  s_lshr_b32 s47, s3, 1
  s_lshl_b32 s47, s47, 2
  s_lshr_b32 s5, s4, 3
  s_add_u32 s47, s47, s5
  s_and_b32 s45, s44, 3

  s_and_b32 s46, s3, 1
  s_lshl_b32 s46, s46, 3
  s_lshr_b32 s5, s4, 2
  s_add_u32 s46, s46, s5
  s_lshr_b32 s47, s3, 1
  s_lshl_b32 s47, s47, 2
  s_and_b32 s5, s4, 3
  s_add_u32 s47, s47, s5

  s_waitcnt lgkmcnt(0)
  s_mov_b32 s8, s64
  s_and_b32 s9, s65, 0xffff
  s_mov_b32 s10, 2097152
  s_mov_b32 s11, 0x20000
  s_mov_b32 s20, s94
  s_and_b32 s21, s95, 0xffff
  s_mov_b32 s22, 15224832
  s_mov_b32 s23, 0x20000
  s_mov_b32 s24, s88
  s_and_b32 s25, s89, 0xffff
  s_mov_b32 s26, 1835008
  s_mov_b32 s27, 0x20000
  s_add_u32 s28, s94, 14434304
  s_addc_u32 s29, s95, 0
  s_and_b32 s29, s29, 0xffff
  s_mov_b32 s30, 393216
  s_mov_b32 s31, 0x20000
  s_cmp_lt_u32 s45, 2
  s_cselect_b32 s12, s70, s72
  s_cselect_b32 s13, s71, s73
  s_and_b32 s13, s13, 0xffff
  s_mov_b32 s14, 524288
  s_mov_b32 s15, 0x20000
  s_cmp_lt_u32 s45, 2
  s_cselect_b32 s16, s84, s86
  s_cselect_b32 s17, s85, s87
  s_and_b32 s17, s17, 0xffff
  s_mov_b32 s18, 1835008
  s_mov_b32 s19, 0x20000
  v_and_b32 v1, 31, v0
  v_lshrrev_b32 v2, 5, v0
  v_bfe_u32 v3, v1, 2, 1
  v_lshlrev_b32 v3, 4, v3
  v_lshrrev_b32 v4, 3, v1
  v_lshl_add_u32 v3, v4, 2, v3
  v_and_b32 v4, 3, v1
  v_add_u32 v3, v3, v4
  v_lshrrev_b32 v7, 3, v0
  v_lshrrev_b32 v8, 4, v0
  v_and_b32 v9, 7, v0
  v_xor_b32 v10, v9, v8
  v_xor_b32 v11, 4, v10
  s_lshl_b32 s5, s46, 7
  s_lshl_b32 s6, s45, 5
  s_add_u32 s5, s5, s6
  v_add_u32 v12, s5, v7
  v_lshlrev_b32 v12, 10, v12
  v_lshl_add_u32 v4, v10, 4, v12
  v_lshl_add_u32 v5, v11, 4, v12
  v_add_u32 v5, 0x2000, v5
  s_lshl_b32 s5, s47, 5
  s_and_b32 s6, s45, 1
  s_lshl_b32 s6, s6, 4
  s_add_u32 s5, s5, s6
  v_add_u32 v12, s5, v7
  v_lshlrev_b32 v12, 10, v12
  v_lshl_add_u32 v6, v10, 4, v12
  v_lshl_add_u32 v7, v11, 4, v12
  v_add_u32 v7, 0x2000, v7
  s_lshr_b32 s62, s46, 1
  s_and_b32 s63, s46, 1

  s_add_u32 s5, s62, 0
  s_and_b32 s5, s5, 7
  s_lshl_b32 s48, s5, 7
  s_add_u32 s5, s62, 1
  s_and_b32 s5, s5, 7
  s_lshl_b32 s49, s5, 7
  s_add_u32 s5, s62, 2
  s_and_b32 s5, s5, 7
  s_lshl_b32 s50, s5, 7
  s_add_u32 s5, s62, 3
  s_and_b32 s5, s5, 7
  s_lshl_b32 s51, s5, 7
  s_add_u32 s5, s62, 4
  s_and_b32 s5, s5, 7
  s_lshl_b32 s52, s5, 7
  s_add_u32 s5, s62, 5
  s_and_b32 s5, s5, 7
  s_lshl_b32 s53, s5, 7
  s_add_u32 s5, s62, 6
  s_and_b32 s5, s5, 7
  s_lshl_b32 s54, s5, 7
  s_add_u32 s5, s62, 7
  s_and_b32 s5, s5, 7
  s_lshl_b32 s55, s5, 7
  s_lshl_b32 s56, s45, 12
  s_lshl_b32 s57, s45, 11
  s_add_u32 s57, s57, 16384
  s_mov_b32 s58, 0x3f803f80
  s_lshl_b32 s61, s46, 2
  s_add_u32 s61, s61, s45
  s_mul_i32 s61, s61, 180224
  s_cmp_ge_u32 s44, 4
  s_cbranch_scc1 LB_c1

  s_lshl_b32 s5, s47, 5
  v_add_u32 v60, s5, v1
  v_lshlrev_b32 v60, 1, v60

  global_load_ushort v61, v60, s[66:67]
  global_load_ushort v62, v60, s[68:69]
  global_load_ushort v63, v60, s[78:79]
  s_mul_i32 s5, s47, 112
  s_lshl_b32 s6, s44, 4
  s_add_u32 s5, s5, s6
  v_lshrrev_b32 v4, 2, v0
  v_add_u32 v4, s5, v4
  v_lshlrev_b32 v4, 10, v4
  v_and_b32 v5, 3, v0
  v_lshl_add_u32 v4, v5, 4, v4
  s_lshl_b32 s5, s46, 6
  v_add_u32 v4, s5, v4
  s_lshl_b32 s5, s44, 10
  s_add_u32 s5, s5, 151680
  s_mov_b32 m0, s5

  buffer_load_dwordx4 v4, s[24:27], 0 offen lds
  s_and_b32 s5, s45, 1
  s_mul_i32 s5, s5, 3
  s_add_u32 s5, s5, 8
  s_lshl_b32 s59, s5, 10
  s_lshl_b32 s5, s5, 6
  s_mul_i32 s6, s47, 224
  s_mov_b32 s7, 0x12492493

  v_add_u32 v48, s5, v0
  v_add_u32 v48, 0, v48
  v_mul_hi_u32 v49, v48, s7
  v_mul_u32_u24 v50, 14, v49
  v_sub_u32 v50, v48, v50
  v_mul_u32_u24 v49, 3584, v49
  v_lshl_add_u32 v49, v50, 4, v49
  v_add_u32 v28, s6, v49

  v_add_u32 v48, s5, v0
  v_add_u32 v48, 64, v48
  v_mul_hi_u32 v49, v48, s7
  v_mul_u32_u24 v50, 14, v49
  v_sub_u32 v50, v48, v50
  v_mul_u32_u24 v49, 3584, v49
  v_lshl_add_u32 v49, v50, 4, v49
  v_add_u32 v29, s6, v49

  v_add_u32 v48, s5, v0
  v_add_u32 v48, 128, v48
  v_mul_hi_u32 v49, v48, s7
  v_mul_u32_u24 v50, 14, v49
  v_sub_u32 v50, v48, v50
  v_mul_u32_u24 v49, 3584, v49
  v_lshl_add_u32 v49, v50, 4, v49
  v_add_u32 v30, s6, v49

  s_lshr_b32 s5, s45, 1
  s_mul_i32 s5, s5, 14464
  s_add_u32 s59, s59, s5

  s_mul_i32 s72, s48, 1792
  s_mul_i32 s73, s49, 1792
  s_mul_i32 s74, s50, 1792
  s_mul_i32 s75, s51, 1792
  s_mul_i32 s76, s52, 1792
  s_mul_i32 s77, s53, 1792
  s_mul_i32 s78, s54, 1792
  s_mul_i32 s79, s55, 1792
  s_lshl_b32 s5, s45, 5
  v_add_u32 v4, s5, v3
  v_bfe_u32 v5, v4, 1, 3
  v_xor_b32 v5, v5, v2
  v_lshlrev_b32 v5, 4, v5
  v_lshl_add_u32 v8, v4, 7, v5
  v_xor_b32 v9, 32, v8
  v_xor_b32 v10, 64, v8
  v_xor_b32 v11, 96, v8

  v_bfe_u32 v12, v1, 1, 3
  v_xor_b32 v12, v12, v2
  v_lshlrev_b32 v12, 4, v12
  v_lshl_add_u32 v48, v1, 7, v12
  v_add_u32 v48, 16384, v48
  v_xor_b32 v49, 32, v48
  v_xor_b32 v50, 64, v48
  v_xor_b32 v51, 96, v48

  v_bfe_u32 v12, v0, 2, 2
  v_lshl_add_u32 v12, v2, 3, v12
  v_mul_u32_u24 v46, 224, v12
  v_and_b32 v12, 3, v0
  v_lshl_add_u32 v46, v12, 3, v46
  v_bfe_u32 v12, v0, 4, 1
  v_mul_u32_u24 v12, 14464, v12
  v_add_u32 v46, v46, v12

  v_mov_b32 v96, 0
  v_mov_b32 v97, 0
  v_mov_b32 v98, 0
  v_mov_b32 v99, 0
  v_mov_b32 v100, 0
  v_mov_b32 v101, 0
  v_mov_b32 v102, 0
  v_mov_b32 v103, 0
  v_mov_b32 v104, 0
  v_mov_b32 v105, 0
  v_mov_b32 v106, 0
  v_mov_b32 v107, 0
  v_mov_b32 v108, 0
  v_mov_b32 v109, 0
  v_mov_b32 v110, 0
  v_mov_b32 v111, 0
  v_mov_b32 v112, 0
  v_mov_b32 v113, 0
  v_mov_b32 v114, 0
  v_mov_b32 v115, 0
  v_mov_b32 v116, 0
  v_mov_b32 v117, 0
  v_mov_b32 v118, 0
  v_mov_b32 v119, 0
  v_mov_b32 v120, 0
  v_mov_b32 v121, 0
  v_mov_b32 v122, 0
  v_mov_b32 v123, 0
  v_mov_b32 v124, 0
  v_mov_b32 v125, 0
  v_mov_b32 v126, 0
  v_mov_b32 v127, 0
  v_mov_b32 v12, 0
  v_mov_b32 v13, 0
  v_mov_b32 v14, 0
  v_mov_b32 v15, 0
  s_barrier
  ds_read_b128 a[0:3], v8 offset:0
  ds_read_b128 v[16:19], v48 offset:0
  ds_read_b128 v[20:23], v48 offset:4096
  ds_read_b128 a[4:7], v9 offset:0
  ds_read_b128 v[64:67], v49 offset:0
  ds_read_b128 v[68:71], v49 offset:4096
  ds_read_b128 a[8:11], v10 offset:0
  ds_read_b128 v[72:75], v50 offset:0
  ds_read_b128 v[76:79], v50 offset:4096
  ds_read_b128 a[12:15], v11 offset:0
  ds_read_b128 v[80:83], v51 offset:0
  ds_read_b128 v[84:87], v51 offset:4096
  s_waitcnt lgkmcnt(9)
  v_mfma_f32_32x32x16_bf16 v[96:111], a[0:3], v[16:19], v[96:111]
  v_mfma_f32_32x32x16_bf16 v[112:127], a[0:3], v[20:23], v[112:127]
  s_cmp_lg_u32 s45, 0
  s_cbranch_scc1 LB_bs_0_0
  v_dot2c_f32_bf16 v14, s58, v16
  v_dot2c_f32_bf16 v15, s58, v20
  v_dot2c_f32_bf16 v14, s58, v17
  v_dot2c_f32_bf16 v15, s58, v21
  v_dot2c_f32_bf16 v14, s58, v18
  v_dot2c_f32_bf16 v15, s58, v22
  v_dot2c_f32_bf16 v14, s58, v19
  v_dot2c_f32_bf16 v15, s58, v23
LB_bs_0_0:
  s_barrier
  s_waitcnt vmcnt(0)
  v_bfe_u32 v56, v0, 2, 2
  v_lshl_add_u32 v56, v2, 2, v56
  v_lshlrev_b32 v56, 6, v56
  v_bfe_u32 v57, v0, 4, 1
  v_lshl_add_u32 v56, v57, 5, v56
  v_and_b32 v57, 3, v0
  v_lshl_add_u32 v56, v57, 3, v56
  s_lshl_b32 s5, s44, 10
  s_add_u32 s5, s5, 151680
  v_add_u32 v56, s5, v56
  ds_read_b64_tr_b16 v[52:53], v56
  ds_read_b64_tr_b16 v[54:55], v56 offset:512
  s_mul_i32 s5, s46, 180224
  s_mul_i32 s6, s47, 7
  s_add_u32 s6, s6, s44
  s_lshl_b32 s6, s6, 10
  s_add_u32 s5, s5, s6
  s_add_u32 s5, s5, 11534336
  v_lshlrev_b32 v57, 4, v0
  s_waitcnt lgkmcnt(0)

  buffer_store_dwordx4 v[52:55], v57, s[20:23], s5 offen sc1
  s_cmp_lg_u32 s44, 0
  s_cbranch_scc1 LB_nonon
  s_or_b32 s96, s96, 1
  s_or_b32 s97, s97, 1
  v_mov_b32 v52, s96
  v_mov_b32 v53, s97
  v_mov_b32 v54, 0
  v_mov_b32 v55, 0
  v_mov_b32 v56, 0
  s_mov_b64 exec, 1
  global_atomic_cmpswap_x2 v[58:59], v56, v[52:55], s[92:93] sc0 sc1
  s_mov_b64 exec, -1

LB_nonon:
  ds_read_b128 a[16:19], v8 offset:24576
  ds_read_b128 v[16:19], v48 offset:24576
  ds_read_b128 v[20:23], v48 offset:28672
  s_waitcnt lgkmcnt(9)
  v_mfma_f32_32x32x16_bf16 v[96:111], a[4:7], v[64:67], v[96:111]
  v_mfma_f32_32x32x16_bf16 v[112:127], a[4:7], v[68:71], v[112:127]
  s_cmp_lg_u32 s45, 1
  s_cbranch_scc1 LB_bs_0_1
  v_dot2c_f32_bf16 v14, s58, v64
  v_dot2c_f32_bf16 v15, s58, v68
  v_dot2c_f32_bf16 v14, s58, v65
  v_dot2c_f32_bf16 v15, s58, v69
  v_dot2c_f32_bf16 v14, s58, v66
  v_dot2c_f32_bf16 v15, s58, v70
  v_dot2c_f32_bf16 v14, s58, v67
  v_dot2c_f32_bf16 v15, s58, v71
LB_bs_0_1:
  s_add_u32 m0, s59, 122880
  s_nop 0
  buffer_load_dwordx4 v28, s[16:19], s72 offen lds
  ds_read_b128 a[20:23], v9 offset:24576
  ds_read_b128 v[64:67], v49 offset:24576
  ds_read_b128 v[68:71], v49 offset:28672
  s_waitcnt lgkmcnt(9)
  v_mfma_f32_32x32x16_bf16 v[96:111], a[8:11], v[72:75], v[96:111]
  v_mfma_f32_32x32x16_bf16 v[112:127], a[8:11], v[76:79], v[112:127]
  s_cmp_lg_u32 s45, 2
  s_cbranch_scc1 LB_bs_0_2
  v_dot2c_f32_bf16 v14, s58, v72
  v_dot2c_f32_bf16 v15, s58, v76
  v_dot2c_f32_bf16 v14, s58, v73
  v_dot2c_f32_bf16 v15, s58, v77
  v_dot2c_f32_bf16 v14, s58, v74
  v_dot2c_f32_bf16 v15, s58, v78
  v_dot2c_f32_bf16 v14, s58, v75
  v_dot2c_f32_bf16 v15, s58, v79
LB_bs_0_2:
  s_add_u32 m0, s59, 123904
  s_nop 0
  buffer_load_dwordx4 v29, s[16:19], s72 offen lds
  ds_read_b128 a[24:27], v10 offset:24576
  ds_read_b128 v[72:75], v50 offset:24576
  ds_read_b128 v[76:79], v50 offset:28672
  s_waitcnt lgkmcnt(9)
  v_mfma_f32_32x32x16_bf16 v[96:111], a[12:15], v[80:83], v[96:111]
  v_mfma_f32_32x32x16_bf16 v[112:127], a[12:15], v[84:87], v[112:127]
  s_cmp_lg_u32 s45, 3
  s_cbranch_scc1 LB_bs_0_3
  v_dot2c_f32_bf16 v14, s58, v80
  v_dot2c_f32_bf16 v15, s58, v84
  v_dot2c_f32_bf16 v14, s58, v81
  v_dot2c_f32_bf16 v15, s58, v85
  v_dot2c_f32_bf16 v14, s58, v82
  v_dot2c_f32_bf16 v15, s58, v86
  v_dot2c_f32_bf16 v14, s58, v83
  v_dot2c_f32_bf16 v15, s58, v87
LB_bs_0_3:
  s_add_u32 m0, s59, 124928
  s_nop 0
  buffer_load_dwordx4 v30, s[16:19], s72 offen lds
  ds_read_b128 a[28:31], v11 offset:24576
  ds_read_b128 v[80:83], v51 offset:24576
  ds_read_b128 v[84:87], v51 offset:28672
  s_waitcnt lgkmcnt(9)
  v_mfma_f32_32x32x16_bf16 v[96:111], a[16:19], v[16:19], v[96:111]
  v_mfma_f32_32x32x16_bf16 v[112:127], a[16:19], v[20:23], v[112:127]
  s_cmp_lg_u32 s45, 0
  s_cbranch_scc1 LB_bs_1_0
  v_dot2c_f32_bf16 v14, s58, v16
  v_dot2c_f32_bf16 v15, s58, v20
  v_dot2c_f32_bf16 v14, s58, v17
  v_dot2c_f32_bf16 v15, s58, v21
  v_dot2c_f32_bf16 v14, s58, v18
  v_dot2c_f32_bf16 v15, s58, v22
  v_dot2c_f32_bf16 v14, s58, v19
  v_dot2c_f32_bf16 v15, s58, v23
LB_bs_1_0:
  s_barrier
  ds_read_b128 a[32:35], v8 offset:49152
  ds_read_b128 v[16:19], v48 offset:49152
  ds_read_b128 v[20:23], v48 offset:53248
  s_waitcnt lgkmcnt(9)
  v_mfma_f32_32x32x16_bf16 v[96:111], a[20:23], v[64:67], v[96:111]
  v_mfma_f32_32x32x16_bf16 v[112:127], a[20:23], v[68:71], v[112:127]
  s_cmp_lg_u32 s45, 1
  s_cbranch_scc1 LB_bs_1_1
  v_dot2c_f32_bf16 v14, s58, v64
  v_dot2c_f32_bf16 v15, s58, v68
  v_dot2c_f32_bf16 v14, s58, v65
  v_dot2c_f32_bf16 v15, s58, v69
  v_dot2c_f32_bf16 v14, s58, v66
  v_dot2c_f32_bf16 v15, s58, v70
  v_dot2c_f32_bf16 v14, s58, v67
  v_dot2c_f32_bf16 v15, s58, v71
LB_bs_1_1:
  ds_read_b128 a[36:39], v9 offset:49152
  ds_read_b128 v[64:67], v49 offset:49152
  ds_read_b128 v[68:71], v49 offset:53248
  s_waitcnt lgkmcnt(9)
  v_mfma_f32_32x32x16_bf16 v[96:111], a[24:27], v[72:75], v[96:111]
  v_mfma_f32_32x32x16_bf16 v[112:127], a[24:27], v[76:79], v[112:127]
  s_cmp_lg_u32 s45, 2
  s_cbranch_scc1 LB_bs_1_2
  v_dot2c_f32_bf16 v14, s58, v72
  v_dot2c_f32_bf16 v15, s58, v76
  v_dot2c_f32_bf16 v14, s58, v73
  v_dot2c_f32_bf16 v15, s58, v77
  v_dot2c_f32_bf16 v14, s58, v74
  v_dot2c_f32_bf16 v15, s58, v78
  v_dot2c_f32_bf16 v14, s58, v75
  v_dot2c_f32_bf16 v15, s58, v79
LB_bs_1_2:
  ds_read_b128 a[40:43], v10 offset:49152
  ds_read_b128 v[72:75], v50 offset:49152
  ds_read_b128 v[76:79], v50 offset:53248
  s_waitcnt lgkmcnt(9)
  v_mfma_f32_32x32x16_bf16 v[96:111], a[28:31], v[80:83], v[96:111]
  v_mfma_f32_32x32x16_bf16 v[112:127], a[28:31], v[84:87], v[112:127]
  s_cmp_lg_u32 s45, 3
  s_cbranch_scc1 LB_bs_1_3
  v_dot2c_f32_bf16 v14, s58, v80
  v_dot2c_f32_bf16 v15, s58, v84
  v_dot2c_f32_bf16 v14, s58, v81
  v_dot2c_f32_bf16 v15, s58, v85
  v_dot2c_f32_bf16 v14, s58, v82
  v_dot2c_f32_bf16 v15, s58, v86
  v_dot2c_f32_bf16 v14, s58, v83
  v_dot2c_f32_bf16 v15, s58, v87
LB_bs_1_3:
  ds_read_b128 a[44:47], v11 offset:49152
  ds_read_b128 v[80:83], v51 offset:49152
  ds_read_b128 v[84:87], v51 offset:53248
  s_waitcnt lgkmcnt(9)
  v_mfma_f32_32x32x16_bf16 v[96:111], a[32:35], v[16:19], v[96:111]
  v_mfma_f32_32x32x16_bf16 v[112:127], a[32:35], v[20:23], v[112:127]
  s_cmp_lg_u32 s45, 0
  s_cbranch_scc1 LB_bs_2_0
  v_dot2c_f32_bf16 v14, s58, v16
  v_dot2c_f32_bf16 v15, s58, v20
  v_dot2c_f32_bf16 v14, s58, v17
  v_dot2c_f32_bf16 v15, s58, v21
  v_dot2c_f32_bf16 v14, s58, v18
  v_dot2c_f32_bf16 v15, s58, v22
  v_dot2c_f32_bf16 v14, s58, v19
  v_dot2c_f32_bf16 v15, s58, v23
LB_bs_2_0:
  s_barrier
  v_add_u32 v8, 73728, v8
  v_add_u32 v48, 73728, v48
  v_add_u32 v9, 73728, v9
  v_add_u32 v49, 73728, v49
  v_add_u32 v10, 73728, v10
  v_add_u32 v50, 73728, v50
  v_add_u32 v11, 73728, v11
  v_add_u32 v51, 73728, v51
  ds_read_b128 a[48:51], v8 offset:0
  ds_read_b128 v[16:19], v48 offset:0
  ds_read_b128 v[20:23], v48 offset:4096
  s_waitcnt lgkmcnt(9)
  v_mfma_f32_32x32x16_bf16 v[96:111], a[36:39], v[64:67], v[96:111]
  v_mfma_f32_32x32x16_bf16 v[112:127], a[36:39], v[68:71], v[112:127]
  s_cmp_lg_u32 s45, 1
  s_cbranch_scc1 LB_bs_2_1
  v_dot2c_f32_bf16 v14, s58, v64
  v_dot2c_f32_bf16 v15, s58, v68
  v_dot2c_f32_bf16 v14, s58, v65
  v_dot2c_f32_bf16 v15, s58, v69
  v_dot2c_f32_bf16 v14, s58, v66
  v_dot2c_f32_bf16 v15, s58, v70
  v_dot2c_f32_bf16 v14, s58, v67
  v_dot2c_f32_bf16 v15, s58, v71
LB_bs_2_1:
  ds_read_b128 a[52:55], v9 offset:0
  ds_read_b128 v[64:67], v49 offset:0
  ds_read_b128 v[68:71], v49 offset:4096
  s_waitcnt lgkmcnt(9)
  v_mfma_f32_32x32x16_bf16 v[96:111], a[40:43], v[72:75], v[96:111]
  v_mfma_f32_32x32x16_bf16 v[112:127], a[40:43], v[76:79], v[112:127]
  s_cmp_lg_u32 s45, 2
  s_cbranch_scc1 LB_bs_2_2
  v_dot2c_f32_bf16 v14, s58, v72
  v_dot2c_f32_bf16 v15, s58, v76
  v_dot2c_f32_bf16 v14, s58, v73
  v_dot2c_f32_bf16 v15, s58, v77
  v_dot2c_f32_bf16 v14, s58, v74
  v_dot2c_f32_bf16 v15, s58, v78
  v_dot2c_f32_bf16 v14, s58, v75
  v_dot2c_f32_bf16 v15, s58, v79
LB_bs_2_2:
  ds_read_b128 a[56:59], v10 offset:0
  ds_read_b128 v[72:75], v50 offset:0
  ds_read_b128 v[76:79], v50 offset:4096
  s_waitcnt lgkmcnt(9)
  v_mfma_f32_32x32x16_bf16 v[96:111], a[44:47], v[80:83], v[96:111]
  v_mfma_f32_32x32x16_bf16 v[112:127], a[44:47], v[84:87], v[112:127]
  s_cmp_lg_u32 s45, 3
  s_cbranch_scc1 LB_bs_2_3
  v_dot2c_f32_bf16 v14, s58, v80
  v_dot2c_f32_bf16 v15, s58, v84
  v_dot2c_f32_bf16 v14, s58, v81
  v_dot2c_f32_bf16 v15, s58, v85
  v_dot2c_f32_bf16 v14, s58, v82
  v_dot2c_f32_bf16 v15, s58, v86
  v_dot2c_f32_bf16 v14, s58, v83
  v_dot2c_f32_bf16 v15, s58, v87
LB_bs_2_3:
  ds_read_b128 a[60:63], v11 offset:0
  ds_read_b128 v[80:83], v51 offset:0
  ds_read_b128 v[84:87], v51 offset:4096
  s_waitcnt lgkmcnt(9)
  v_mfma_f32_32x32x16_bf16 v[96:111], a[48:51], v[16:19], v[96:111]
  v_mfma_f32_32x32x16_bf16 v[112:127], a[48:51], v[20:23], v[112:127]
  s_cmp_lg_u32 s45, 0
  s_cbranch_scc1 LB_bs_3_0
  v_dot2c_f32_bf16 v14, s58, v16
  v_dot2c_f32_bf16 v15, s58, v20
  v_dot2c_f32_bf16 v14, s58, v17
  v_dot2c_f32_bf16 v15, s58, v21
  v_dot2c_f32_bf16 v14, s58, v18
  v_dot2c_f32_bf16 v15, s58, v22
  v_dot2c_f32_bf16 v14, s58, v19
  v_dot2c_f32_bf16 v15, s58, v23
LB_bs_3_0:
  v_lshlrev_b32 v61, 16, v61
  v_lshlrev_b32 v62, 16, v62
  v_lshlrev_b32 v63, 16, v63
  v_mul_f32 v63, 0x3fb8aa3b, v63
  v_exp_f32 v63, v63
  s_nop 0
  v_cvt_pk_bf16_f32 v63, v63, v63
  v_and_b32 v63, 0xffff0000, v63
  v_mul_f32 v42, v63, v61
  v_mul_f32 v43, v63, v62
  v_mul_f32 v42, 0x3fb8aa3b, v42
  v_exp_f32 v42, v42
  v_mul_f32 v43, 0.15915494, v43
  v_fract_f32 v43, v43
  v_cos_f32 v44, v43
  v_sin_f32 v45, v43
  s_nop 0
  v_mul_f32 v34, v42, v44
  v_mul_f32 v35, v42, v45
  v_add_f32 v42, -1.0, v34
  v_mul_f32 v43, v61, v61
  v_fma_f32 v43, v62, v62, v43
  v_rcp_f32 v43, v43
  v_mul_f32 v44, v42, v61
  v_fma_f32 v44, v35, v62, v44
  v_mul_f32 v45, v35, v61
  v_fma_f32 v45, -v42, v62, v45
  v_add_f32 v43, v43, v43
  v_mul_f32 v40, v44, v43
  v_mul_f32 v41, v45, v43
  v_mov_b32 v36, v34
  v_mov_b32 v37, v35

  v_mul_f32 v60, v36, v36
  v_mul_f32 v61, v36, v37
  v_fma_f32 v60, -v37, v37, v60
  v_fma_f32 v61, v37, v36, v61
  v_mov_b32 v36, v60
  v_mov_b32 v37, v61

  v_mul_f32 v60, v36, v36
  v_mul_f32 v61, v36, v37
  v_fma_f32 v60, -v37, v37, v60
  v_fma_f32 v61, v37, v36, v61
  v_mov_b32 v36, v60
  v_mov_b32 v37, v61

  v_mul_f32 v60, v36, v36
  v_mul_f32 v61, v36, v37
  v_fma_f32 v60, -v37, v37, v60
  v_fma_f32 v61, v37, v36, v61
  v_mov_b32 v36, v60
  v_mov_b32 v37, v61

  v_mul_f32 v60, v36, v36
  v_mul_f32 v61, v36, v37
  v_fma_f32 v60, -v37, v37, v60
  v_fma_f32 v61, v37, v36, v61
  v_mov_b32 v36, v60
  v_mov_b32 v37, v61

  v_mov_b32 v38, v36
  v_mov_b32 v39, v37
  v_mul_f32 v60, v38, v38
  v_mul_f32 v61, v38, v39
  v_fma_f32 v60, -v39, v39, v60
  v_fma_f32 v61, v39, v38, v61
  v_mov_b32 v38, v60
  v_mov_b32 v39, v61

  v_mul_f32 v60, v38, v38
  v_mul_f32 v61, v38, v39
  v_fma_f32 v60, -v39, v39, v60
  v_fma_f32 v61, v39, v38, v61
  v_mov_b32 v38, v60
  v_mov_b32 v39, v61

  v_mul_f32 v60, v38, v38
  v_mul_f32 v61, v38, v39
  v_fma_f32 v60, -v39, v39, v60
  v_fma_f32 v61, v39, v38, v61
  v_mov_b32 v38, v60
  v_mov_b32 v39, v61

  v_mov_b32 v42, 1.0
  v_mov_b32 v43, 0
  s_cmp_lt_u32 s45, 1
  s_cbranch_scc1 LB_ls_done
  v_mul_f32 v60, v42, v36
  v_mul_f32 v61, v42, v37
  v_fma_f32 v60, -v43, v37, v60
  v_fma_f32 v61, v43, v36, v61
  v_mov_b32 v42, v60
  v_mov_b32 v43, v61

  v_mul_f32 v60, v42, v36
  v_mul_f32 v61, v42, v37
  v_fma_f32 v60, -v43, v37, v60
  v_fma_f32 v61, v43, v36, v61
  v_mov_b32 v42, v60
  v_mov_b32 v43, v61

  s_cmp_lt_u32 s45, 2
  s_cbranch_scc1 LB_ls_done
  v_mul_f32 v60, v42, v36
  v_mul_f32 v61, v42, v37
  v_fma_f32 v60, -v43, v37, v60
  v_fma_f32 v61, v43, v36, v61
  v_mov_b32 v42, v60
  v_mov_b32 v43, v61

  v_mul_f32 v60, v42, v36
  v_mul_f32 v61, v42, v37
  v_fma_f32 v60, -v43, v37, v60
  v_fma_f32 v61, v43, v36, v61
  v_mov_b32 v42, v60
  v_mov_b32 v43, v61

  s_cmp_lt_u32 s45, 3
  s_cbranch_scc1 LB_ls_done
  v_mul_f32 v60, v42, v36
  v_mul_f32 v61, v42, v37
  v_fma_f32 v60, -v43, v37, v60
  v_fma_f32 v61, v43, v36, v61
  v_mov_b32 v42, v60
  v_mov_b32 v43, v61

  v_mul_f32 v60, v42, v36
  v_mul_f32 v61, v42, v37
  v_fma_f32 v60, -v43, v37, v60
  v_fma_f32 v61, v43, v36, v61
  v_mov_b32 v42, v60
  v_mov_b32 v43, v61

LB_ls_done:
  v_mul_f32 v60, v42, v36
  v_mul_f32 v61, v42, v37
  v_fma_f32 v60, -v43, v37, v60
  v_fma_f32 v61, v43, v36, v61
  v_mov_b32 v62, v60
  v_mov_b32 v63, v61

  v_cmp_gt_u32 vcc, 32, v0
  s_nop 1
  v_cndmask_b32 v42, v62, v42, vcc
  v_cndmask_b32 v43, v63, v43, vcc

  s_barrier
  ds_read_b128 a[64:67], v8 offset:24576
  ds_read_b128 v[16:19], v48 offset:24576
  ds_read_b128 v[20:23], v48 offset:28672
  s_waitcnt lgkmcnt(9)
  v_mfma_f32_32x32x16_bf16 v[96:111], a[52:55], v[64:67], v[96:111]
  v_mfma_f32_32x32x16_bf16 v[112:127], a[52:55], v[68:71], v[112:127]
  s_cmp_lg_u32 s45, 1
  s_cbranch_scc1 LB_bs_3_1
  v_dot2c_f32_bf16 v14, s58, v64
  v_dot2c_f32_bf16 v15, s58, v68
  v_dot2c_f32_bf16 v14, s58, v65
  v_dot2c_f32_bf16 v15, s58, v69
  v_dot2c_f32_bf16 v14, s58, v66
  v_dot2c_f32_bf16 v15, s58, v70
  v_dot2c_f32_bf16 v14, s58, v67
  v_dot2c_f32_bf16 v15, s58, v71
LB_bs_3_1:
  ds_read_b128 a[68:71], v9 offset:24576
  ds_read_b128 v[64:67], v49 offset:24576
  ds_read_b128 v[68:71], v49 offset:28672
  s_waitcnt lgkmcnt(9)
  v_mfma_f32_32x32x16_bf16 v[96:111], a[56:59], v[72:75], v[96:111]
  v_mfma_f32_32x32x16_bf16 v[112:127], a[56:59], v[76:79], v[112:127]
  s_cmp_lg_u32 s45, 2
  s_cbranch_scc1 LB_bs_3_2
  v_dot2c_f32_bf16 v14, s58, v72
  v_dot2c_f32_bf16 v15, s58, v76
  v_dot2c_f32_bf16 v14, s58, v73
  v_dot2c_f32_bf16 v15, s58, v77
  v_dot2c_f32_bf16 v14, s58, v74
  v_dot2c_f32_bf16 v15, s58, v78
  v_dot2c_f32_bf16 v14, s58, v75
  v_dot2c_f32_bf16 v15, s58, v79
LB_bs_3_2:
  ds_read_b128 a[72:75], v10 offset:24576
  ds_read_b128 v[72:75], v50 offset:24576
  ds_read_b128 v[76:79], v50 offset:28672
  s_waitcnt lgkmcnt(9)
  v_mfma_f32_32x32x16_bf16 v[96:111], a[60:63], v[80:83], v[96:111]
  v_mfma_f32_32x32x16_bf16 v[112:127], a[60:63], v[84:87], v[112:127]
  s_cmp_lg_u32 s45, 3
  s_cbranch_scc1 LB_bs_3_3
  v_dot2c_f32_bf16 v14, s58, v80
  v_dot2c_f32_bf16 v15, s58, v84
  v_dot2c_f32_bf16 v14, s58, v81
  v_dot2c_f32_bf16 v15, s58, v85
  v_dot2c_f32_bf16 v14, s58, v82
  v_dot2c_f32_bf16 v15, s58, v86
  v_dot2c_f32_bf16 v14, s58, v83
  v_dot2c_f32_bf16 v15, s58, v87
LB_bs_3_3:
  ds_read_b128 a[76:79], v11 offset:24576
  ds_read_b128 v[80:83], v51 offset:24576
  ds_read_b128 v[84:87], v51 offset:28672
  s_waitcnt lgkmcnt(9)
  v_mfma_f32_32x32x16_bf16 v[96:111], a[64:67], v[16:19], v[96:111]
  v_mfma_f32_32x32x16_bf16 v[112:127], a[64:67], v[20:23], v[112:127]
  s_cmp_lg_u32 s45, 0
  s_cbranch_scc1 LB_bs_4_0
  v_dot2c_f32_bf16 v14, s58, v16
  v_dot2c_f32_bf16 v15, s58, v20
  v_dot2c_f32_bf16 v14, s58, v17
  v_dot2c_f32_bf16 v15, s58, v21
  v_dot2c_f32_bf16 v14, s58, v18
  v_dot2c_f32_bf16 v15, s58, v22
  v_dot2c_f32_bf16 v14, s58, v19
  v_dot2c_f32_bf16 v15, s58, v23
LB_bs_4_0:
  s_barrier
  s_cmp_lg_u32 s44, 0
  s_cbranch_scc1 LB_nonon2
  s_waitcnt vmcnt(3)
  v_or_b32 v52, v58, v59
  v_cmp_eq_u32 vcc, 0, v52
  v_mov_b32 v52, s96
  v_mov_b32 v53, s97
  v_cndmask_b32 v58, v58, v52, vcc
  v_cndmask_b32 v59, v59, v53, vcc
  v_mov_b32 v52, 160896
  s_mov_b64 exec, 1
  ds_write_b64 v52, v[58:59]
  s_mov_b64 exec, -1
  s_waitcnt lgkmcnt(0)

LB_nonon2:
  v_add_u32 v8, 4294893568, v8
  v_add_u32 v48, 4294893568, v48
  v_add_u32 v9, 4294893568, v9
  v_add_u32 v49, 4294893568, v49
  v_add_u32 v10, 4294893568, v10
  v_add_u32 v50, 4294893568, v50
  v_add_u32 v11, 4294893568, v11
  v_add_u32 v51, 4294893568, v51
  ds_read_b128 a[80:83], v8 offset:0
  ds_read_b128 v[16:19], v48 offset:0
  ds_read_b128 v[20:23], v48 offset:4096
  s_waitcnt lgkmcnt(9)
  v_mfma_f32_32x32x16_bf16 v[96:111], a[68:71], v[64:67], v[96:111]
  v_mfma_f32_32x32x16_bf16 v[112:127], a[68:71], v[68:71], v[112:127]
  s_cmp_lg_u32 s45, 1
  s_cbranch_scc1 LB_bs_4_1
  v_dot2c_f32_bf16 v14, s58, v64
  v_dot2c_f32_bf16 v15, s58, v68
  v_dot2c_f32_bf16 v14, s58, v65
  v_dot2c_f32_bf16 v15, s58, v69
  v_dot2c_f32_bf16 v14, s58, v66
  v_dot2c_f32_bf16 v15, s58, v70
  v_dot2c_f32_bf16 v14, s58, v67
  v_dot2c_f32_bf16 v15, s58, v71
LB_bs_4_1:
  ds_read_b128 a[84:87], v9 offset:0
  ds_read_b128 v[64:67], v49 offset:0
  ds_read_b128 v[68:71], v49 offset:4096
  s_waitcnt lgkmcnt(9)
  v_mfma_f32_32x32x16_bf16 v[96:111], a[72:75], v[72:75], v[96:111]
  v_mfma_f32_32x32x16_bf16 v[112:127], a[72:75], v[76:79], v[112:127]
  s_cmp_lg_u32 s45, 2
  s_cbranch_scc1 LB_bs_4_2
  v_dot2c_f32_bf16 v14, s58, v72
  v_dot2c_f32_bf16 v15, s58, v76
  v_dot2c_f32_bf16 v14, s58, v73
  v_dot2c_f32_bf16 v15, s58, v77
  v_dot2c_f32_bf16 v14, s58, v74
  v_dot2c_f32_bf16 v15, s58, v78
  v_dot2c_f32_bf16 v14, s58, v75
  v_dot2c_f32_bf16 v15, s58, v79
LB_bs_4_2:
  ds_read_b128 a[88:91], v10 offset:0
  ds_read_b128 v[72:75], v50 offset:0
  ds_read_b128 v[76:79], v50 offset:4096
  s_waitcnt lgkmcnt(9)
  v_mfma_f32_32x32x16_bf16 v[96:111], a[76:79], v[80:83], v[96:111]
  v_mfma_f32_32x32x16_bf16 v[112:127], a[76:79], v[84:87], v[112:127]
  s_cmp_lg_u32 s45, 3
  s_cbranch_scc1 LB_bs_4_3
  v_dot2c_f32_bf16 v14, s58, v80
  v_dot2c_f32_bf16 v15, s58, v84
  v_dot2c_f32_bf16 v14, s58, v81
  v_dot2c_f32_bf16 v15, s58, v85
  v_dot2c_f32_bf16 v14, s58, v82
  v_dot2c_f32_bf16 v15, s58, v86
  v_dot2c_f32_bf16 v14, s58, v83
  v_dot2c_f32_bf16 v15, s58, v87
LB_bs_4_3:
  ds_read_b128 a[92:95], v11 offset:0
  ds_read_b128 v[80:83], v51 offset:0
  ds_read_b128 v[84:87], v51 offset:4096
  s_waitcnt lgkmcnt(9)
  v_mfma_f32_32x32x16_bf16 v[96:111], a[80:83], v[16:19], v[96:111]
  v_mfma_f32_32x32x16_bf16 v[112:127], a[80:83], v[20:23], v[112:127]
  s_cmp_lg_u32 s45, 0
  s_cbranch_scc1 LB_bs_5_0
  v_dot2c_f32_bf16 v14, s58, v16
  v_dot2c_f32_bf16 v15, s58, v20
  v_dot2c_f32_bf16 v14, s58, v17
  v_dot2c_f32_bf16 v15, s58, v21
  v_dot2c_f32_bf16 v14, s58, v18
  v_dot2c_f32_bf16 v15, s58, v22
  v_dot2c_f32_bf16 v14, s58, v19
  v_dot2c_f32_bf16 v15, s58, v23
LB_bs_5_0:
  s_barrier
  v_mov_b32 v56, 160896
  ds_read_b128 v[52:55], v56
  s_waitcnt lgkmcnt(0)
  v_readfirstlane_b32 s96, v52
  v_readfirstlane_b32 s97, v53
  v_readfirstlane_b32 s98, v54
  v_readfirstlane_b32 s99, v55

  s_lshl_b32 s5, s63, 7
  s_lshl_b32 s6, s45, 5
  s_add_u32 s5, s5, s6
  v_add_u32 v60, s5, v1
  v_lshlrev_b32 v61, 4, v60
  v_add_u32 v61, 155776, v61
  ds_read_b128 v[52:55], v61
  s_movk_i32 s3, 224
  v_cmp_gt_u32 s[6:7], s3, v60
  v_cmp_gt_u32 vcc, 32, v0
  v_lshlrev_b32 v60, 6, v60
  s_mul_i32 s5, s47, 14336
  s_lshl_b32 s3, s62, 3
  s_add_u32 s5, s5, s3
  s_add_u32 s5, s5, 131072
  s_and_b64 vcc, vcc, s[6:7]
  s_waitcnt lgkmcnt(0)
  v_add_f32 v52, v52, v53
  v_add_f32 v54, v54, v55
  v_add_f32 v52, v52, v54
  v_mov_b32 v53, s96
  s_mov_b64 exec, vcc
  s_cbranch_execz LB_nocsp
  buffer_store_dwordx2 v[52:53], v60, s[28:31], s5 offen sc1

LB_nocsp:
  s_mov_b64 exec, -1
  ds_read_b128 a[96:99], v8 offset:24576
  ds_read_b128 v[16:19], v48 offset:24576
  ds_read_b128 v[20:23], v48 offset:28672
  s_waitcnt lgkmcnt(9)
  v_mfma_f32_32x32x16_bf16 v[96:111], a[84:87], v[64:67], v[96:111]
  v_mfma_f32_32x32x16_bf16 v[112:127], a[84:87], v[68:71], v[112:127]
  s_cmp_lg_u32 s45, 1
  s_cbranch_scc1 LB_bs_5_1
  v_dot2c_f32_bf16 v14, s58, v64
  v_dot2c_f32_bf16 v15, s58, v68
  v_dot2c_f32_bf16 v14, s58, v65
  v_dot2c_f32_bf16 v15, s58, v69
  v_dot2c_f32_bf16 v14, s58, v66
  v_dot2c_f32_bf16 v15, s58, v70
  v_dot2c_f32_bf16 v14, s58, v67
  v_dot2c_f32_bf16 v15, s58, v71
LB_bs_5_1:
  s_add_u32 m0, s59, 86400
  s_nop 0
  buffer_load_dwordx4 v28, s[16:19], s73 offen lds
  ds_read_b128 a[100:103], v9 offset:24576
  ds_read_b128 v[64:67], v49 offset:24576
  ds_read_b128 v[68:71], v49 offset:28672
  s_waitcnt lgkmcnt(9)
  v_mfma_f32_32x32x16_bf16 v[96:111], a[88:91], v[72:75], v[96:111]
  v_mfma_f32_32x32x16_bf16 v[112:127], a[88:91], v[76:79], v[112:127]
  s_cmp_lg_u32 s45, 2
  s_cbranch_scc1 LB_bs_5_2
  v_dot2c_f32_bf16 v14, s58, v72
  v_dot2c_f32_bf16 v15, s58, v76
  v_dot2c_f32_bf16 v14, s58, v73
  v_dot2c_f32_bf16 v15, s58, v77
  v_dot2c_f32_bf16 v14, s58, v74
  v_dot2c_f32_bf16 v15, s58, v78
  v_dot2c_f32_bf16 v14, s58, v75
  v_dot2c_f32_bf16 v15, s58, v79
LB_bs_5_2:
  s_add_u32 m0, s59, 87424
  s_nop 0
  buffer_load_dwordx4 v29, s[16:19], s73 offen lds
  ds_read_b128 a[104:107], v10 offset:24576
  ds_read_b128 v[72:75], v50 offset:24576
  ds_read_b128 v[76:79], v50 offset:28672
  s_waitcnt lgkmcnt(9)
  v_mfma_f32_32x32x16_bf16 v[96:111], a[92:95], v[80:83], v[96:111]
  v_mfma_f32_32x32x16_bf16 v[112:127], a[92:95], v[84:87], v[112:127]
  s_cmp_lg_u32 s45, 3
  s_cbranch_scc1 LB_bs_5_3
  v_dot2c_f32_bf16 v14, s58, v80
  v_dot2c_f32_bf16 v15, s58, v84
  v_dot2c_f32_bf16 v14, s58, v81
  v_dot2c_f32_bf16 v15, s58, v85
  v_dot2c_f32_bf16 v14, s58, v82
  v_dot2c_f32_bf16 v15, s58, v86
  v_dot2c_f32_bf16 v14, s58, v83
  v_dot2c_f32_bf16 v15, s58, v87
LB_bs_5_3:
  s_add_u32 m0, s59, 88448
  s_nop 0
  buffer_load_dwordx4 v30, s[16:19], s73 offen lds
  ds_read_b128 a[108:111], v11 offset:24576
  ds_read_b128 v[80:83], v51 offset:24576
  ds_read_b128 v[84:87], v51 offset:28672
  s_waitcnt lgkmcnt(9)
  v_mfma_f32_32x32x16_bf16 v[96:111], a[96:99], v[16:19], v[96:111]
  v_mfma_f32_32x32x16_bf16 v[112:127], a[96:99], v[20:23], v[112:127]
  s_cmp_lg_u32 s45, 0
  s_cbranch_scc1 LB_bs_6_0
  v_dot2c_f32_bf16 v14, s58, v16
  v_dot2c_f32_bf16 v15, s58, v20
  v_dot2c_f32_bf16 v14, s58, v17
  v_dot2c_f32_bf16 v15, s58, v21
  v_dot2c_f32_bf16 v14, s58, v18
  v_dot2c_f32_bf16 v15, s58, v22
  v_dot2c_f32_bf16 v14, s58, v19
  v_dot2c_f32_bf16 v15, s58, v23
LB_bs_6_0:
  s_barrier
  ds_read_b128 a[112:115], v8 offset:49152
  ds_read_b128 v[16:19], v48 offset:49152
  ds_read_b128 v[20:23], v48 offset:53248
  s_waitcnt lgkmcnt(9)
  v_mfma_f32_32x32x16_bf16 v[96:111], a[100:103], v[64:67], v[96:111]
  v_mfma_f32_32x32x16_bf16 v[112:127], a[100:103], v[68:71], v[112:127]
  s_cmp_lg_u32 s45, 1
  s_cbranch_scc1 LB_bs_6_1
  v_dot2c_f32_bf16 v14, s58, v64
  v_dot2c_f32_bf16 v15, s58, v68
  v_dot2c_f32_bf16 v14, s58, v65
  v_dot2c_f32_bf16 v15, s58, v69
  v_dot2c_f32_bf16 v14, s58, v66
  v_dot2c_f32_bf16 v15, s58, v70
  v_dot2c_f32_bf16 v14, s58, v67
  v_dot2c_f32_bf16 v15, s58, v71
LB_bs_6_1:
  ds_read_b128 a[116:119], v9 offset:49152
  ds_read_b128 v[64:67], v49 offset:49152
  ds_read_b128 v[68:71], v49 offset:53248
  s_waitcnt lgkmcnt(9)
  v_mfma_f32_32x32x16_bf16 v[96:111], a[104:107], v[72:75], v[96:111]
  v_mfma_f32_32x32x16_bf16 v[112:127], a[104:107], v[76:79], v[112:127]
  s_cmp_lg_u32 s45, 2
  s_cbranch_scc1 LB_bs_6_2
  v_dot2c_f32_bf16 v14, s58, v72
  v_dot2c_f32_bf16 v15, s58, v76
  v_dot2c_f32_bf16 v14, s58, v73
  v_dot2c_f32_bf16 v15, s58, v77
  v_dot2c_f32_bf16 v14, s58, v74
  v_dot2c_f32_bf16 v15, s58, v78
  v_dot2c_f32_bf16 v14, s58, v75
  v_dot2c_f32_bf16 v15, s58, v79
LB_bs_6_2:
  ds_read_b128 a[120:123], v10 offset:49152
  ds_read_b128 v[72:75], v50 offset:49152
  ds_read_b128 v[76:79], v50 offset:53248
  s_waitcnt lgkmcnt(9)
  v_mfma_f32_32x32x16_bf16 v[96:111], a[108:111], v[80:83], v[96:111]
  v_mfma_f32_32x32x16_bf16 v[112:127], a[108:111], v[84:87], v[112:127]
  s_cmp_lg_u32 s45, 3
  s_cbranch_scc1 LB_bs_6_3
  v_dot2c_f32_bf16 v14, s58, v80
  v_dot2c_f32_bf16 v15, s58, v84
  v_dot2c_f32_bf16 v14, s58, v81
  v_dot2c_f32_bf16 v15, s58, v85
  v_dot2c_f32_bf16 v14, s58, v82
  v_dot2c_f32_bf16 v15, s58, v86
  v_dot2c_f32_bf16 v14, s58, v83
  v_dot2c_f32_bf16 v15, s58, v87
LB_bs_6_3:
  ds_read_b128 a[124:127], v11 offset:49152
  ds_read_b128 v[80:83], v51 offset:49152
  ds_read_b128 v[84:87], v51 offset:53248
  s_waitcnt lgkmcnt(9)
  v_mfma_f32_32x32x16_bf16 v[96:111], a[112:115], v[16:19], v[96:111]
  v_mfma_f32_32x32x16_bf16 v[112:127], a[112:115], v[20:23], v[112:127]
  s_cmp_lg_u32 s45, 0
  s_cbranch_scc1 LB_bs_7_0
  v_dot2c_f32_bf16 v14, s58, v16
  v_dot2c_f32_bf16 v15, s58, v20
  v_dot2c_f32_bf16 v14, s58, v17
  v_dot2c_f32_bf16 v15, s58, v21
  v_dot2c_f32_bf16 v14, s58, v18
  v_dot2c_f32_bf16 v15, s58, v22
  v_dot2c_f32_bf16 v14, s58, v19
  v_dot2c_f32_bf16 v15, s58, v23
LB_bs_7_0:
  s_waitcnt lgkmcnt(6)
  v_mfma_f32_32x32x16_bf16 v[96:111], a[116:119], v[64:67], v[96:111]
  v_mfma_f32_32x32x16_bf16 v[112:127], a[116:119], v[68:71], v[112:127]
  s_cmp_lg_u32 s45, 1
  s_cbranch_scc1 LB_bs_7_1
  v_dot2c_f32_bf16 v14, s58, v64
  v_dot2c_f32_bf16 v15, s58, v68
  v_dot2c_f32_bf16 v14, s58, v65
  v_dot2c_f32_bf16 v15, s58, v69
  v_dot2c_f32_bf16 v14, s58, v66
  v_dot2c_f32_bf16 v15, s58, v70
  v_dot2c_f32_bf16 v14, s58, v67
  v_dot2c_f32_bf16 v15, s58, v71
LB_bs_7_1:
  s_waitcnt lgkmcnt(3)
  v_mfma_f32_32x32x16_bf16 v[96:111], a[120:123], v[72:75], v[96:111]
  v_mfma_f32_32x32x16_bf16 v[112:127], a[120:123], v[76:79], v[112:127]
  s_cmp_lg_u32 s45, 2
  s_cbranch_scc1 LB_bs_7_2
  v_dot2c_f32_bf16 v14, s58, v72
  v_dot2c_f32_bf16 v15, s58, v76
  v_dot2c_f32_bf16 v14, s58, v73
  v_dot2c_f32_bf16 v15, s58, v77
  v_dot2c_f32_bf16 v14, s58, v74
  v_dot2c_f32_bf16 v15, s58, v78
  v_dot2c_f32_bf16 v14, s58, v75
  v_dot2c_f32_bf16 v15, s58, v79
LB_bs_7_2:
  s_waitcnt lgkmcnt(0)
  v_mfma_f32_32x32x16_bf16 v[96:111], a[124:127], v[80:83], v[96:111]
  v_mfma_f32_32x32x16_bf16 v[112:127], a[124:127], v[84:87], v[112:127]
  s_cmp_lg_u32 s45, 3
  s_cbranch_scc1 LB_bs_7_3
  v_dot2c_f32_bf16 v14, s58, v80
  v_dot2c_f32_bf16 v15, s58, v84
  v_dot2c_f32_bf16 v14, s58, v81
  v_dot2c_f32_bf16 v15, s58, v85
  v_dot2c_f32_bf16 v14, s58, v82
  v_dot2c_f32_bf16 v15, s58, v86
  v_dot2c_f32_bf16 v14, s58, v83
  v_dot2c_f32_bf16 v15, s58, v87
LB_bs_7_3:
  s_lshl_b32 s5, s45, 2
  s_add_u32 s5, s5, 154752
  v_lshlrev_b32 v65, 4, v1
  v_add_u32 v65, s5, v65

  v_mov_b32 v64, v14
  s_nop 1
  v_permlane32_swap_b32 v14, v64
  s_nop 1
  v_add_f32 v64, v14, v64
  ds_write_b32 v65, v64 offset:0

  v_mov_b32 v64, v15
  s_nop 1
  v_permlane32_swap_b32 v15, v64
  s_nop 1
  v_add_f32 v64, v15, v64
  ds_write_b32 v65, v64 offset:512

  s_waitcnt lgkmcnt(0)
  s_mov_b32 s43, 0
  s_waitcnt vmcnt(3)
  s_barrier
  s_add_u32 m0, s59, 0
  s_nop 0
  buffer_load_dwordx4 v28, s[16:19], s74 offen lds
  s_add_u32 m0, s59, 1024
  s_nop 0
  buffer_load_dwordx4 v29, s[16:19], s74 offen lds
  s_add_u32 m0, s59, 2048
  s_nop 0
  buffer_load_dwordx4 v30, s[16:19], s74 offen lds
  v_lshlrev_b32 v65, 4, v1
  v_add_u32 v65, 154752, v65
  ds_read_b128 v[68:71], v65
  ds_read_b128 v[72:75], v65 offset:512
  s_lshl_b32 s5, s45, 5
  v_add_u32 v64, s5, v3
  v_lshlrev_b32 v64, 3, v64
  v_add_u32 v64, 153728, v64
  ds_read_b64 v[32:33], v64
  v_lshlrev_b32 v64, 4, v2
  v_add_u32 v64, s5, v64
  v_lshlrev_b32 v64, 3, v64
  v_add_u32 v64, 153728, v64

  ds_read2_b32 v[80:81], v64 offset0:1 offset1:3
  ds_read2_b32 v[82:83], v64 offset0:5 offset1:7
  ds_read2_b32 v[84:85], v64 offset0:9 offset1:11
  ds_read2_b32 v[86:87], v64 offset0:13 offset1:15
  ds_read2_b32 v[88:89], v64 offset0:17 offset1:19
  ds_read2_b32 v[90:91], v64 offset0:21 offset1:23
  ds_read2_b32 v[92:93], v64 offset0:25 offset1:27
  ds_read2_b32 v[94:95], v64 offset0:29 offset1:31
  s_waitcnt lgkmcnt(0)
  v_xor_b32 v76, 0x80000000, v32
  v_lshrrev_b32 v77, 16, v76
  v_and_b32 v76, 0xffff0000, v76
  v_or_b32 v76, v76, v77
  v_cmp_gt_u32 vcc, 32, v0
  s_nop 1
  v_cndmask_b32 v76, 0, v76, vcc
  v_cndmask_b32 v77, 0, v77, vcc
  v_mov_b32 v78, 0
  v_mov_b32 v79, 0

  s_waitcnt lgkmcnt(0)
  v_add_f32 v68, v68, v69
  v_add_f32 v70, v70, v71
  v_add_f32 v72, v72, v73
  v_add_f32 v74, v74, v75
  v_add_f32 v14, v68, v70
  v_add_f32 v15, v72, v74

  v_cvt_pk_bf16_f32 v64, v14, v14
  v_and_b32 v65, 0xffff0000, v64
  v_sub_f32 v14, v14, v65
  v_cvt_pk_bf16_f32 v66, v14, v14
  v_and_b32 v66, 0xffff0000, v66
  v_sub_f32 v14, v14, v66
  v_lshrrev_b32 v65, 16, v65
  v_or_b32 v68, v65, v66
  v_cvt_pk_bf16_f32 v69, v14, v14
  v_and_b32 v69, 0xffff, v69
  v_mov_b32 v70, 0
  v_mov_b32 v71, 0
  s_nop 1

  v_mfma_f32_32x32x16_bf16 v[96:111], v[76:79], v[68:71], v[96:111]
  v_cvt_pk_bf16_f32 v64, v15, v15
  v_and_b32 v65, 0xffff0000, v64
  v_sub_f32 v15, v15, v65
  v_cvt_pk_bf16_f32 v66, v15, v15
  v_and_b32 v66, 0xffff0000, v66
  v_sub_f32 v15, v15, v66
  v_lshrrev_b32 v65, 16, v65
  v_or_b32 v72, v65, v66
  v_cvt_pk_bf16_f32 v73, v15, v15
  v_and_b32 v73, 0xffff, v73
  v_mov_b32 v74, 0
  v_mov_b32 v75, 0
  s_nop 1

  v_mfma_f32_32x32x16_bf16 v[112:127], v[76:79], v[72:75], v[112:127]
  s_add_u32 m0, s59, 28800
  s_nop 0
  buffer_load_dwordx4 v28, s[16:19], s75 offen lds
  s_add_u32 m0, s59, 29824
  s_nop 0
  buffer_load_dwordx4 v29, s[16:19], s75 offen lds
  s_add_u32 m0, s59, 30848
  s_nop 0
  buffer_load_dwordx4 v30, s[16:19], s75 offen lds
  s_waitcnt vmcnt(6)
  s_barrier
  s_add_u32 m0, s59, 57600
  s_nop 0
  buffer_load_dwordx4 v28, s[16:19], s76 offen lds
  s_add_u32 m0, s59, 58624
  s_nop 0
  buffer_load_dwordx4 v29, s[16:19], s76 offen lds
  s_add_u32 m0, s59, 59648
  s_nop 0
  buffer_load_dwordx4 v30, s[16:19], s76 offen lds
  s_nop 7
  v_mul_f32 v96, v96, v80
  v_mul_f32 v112, v112, v80
  v_mul_f32 v97, v97, v81
  v_mul_f32 v113, v113, v81
  v_mul_f32 v98, v98, v82
  v_mul_f32 v114, v114, v82
  v_mul_f32 v99, v99, v83
  v_mul_f32 v115, v115, v83
  v_mul_f32 v100, v100, v84
  v_mul_f32 v116, v116, v84
  v_mul_f32 v101, v101, v85
  v_mul_f32 v117, v117, v85
  v_mul_f32 v102, v102, v86
  v_mul_f32 v118, v118, v86
  v_mul_f32 v103, v103, v87
  v_mul_f32 v119, v119, v87
  v_mul_f32 v104, v104, v88
  v_mul_f32 v120, v120, v88
  v_mul_f32 v105, v105, v89
  v_mul_f32 v121, v121, v89
  v_mul_f32 v106, v106, v90
  v_mul_f32 v122, v122, v90
  v_mul_f32 v107, v107, v91
  v_mul_f32 v123, v123, v91
  v_mul_f32 v108, v108, v92
  v_mul_f32 v124, v124, v92
  v_mul_f32 v109, v109, v93
  v_mul_f32 v125, v125, v93
  v_mul_f32 v110, v110, v94
  v_mul_f32 v126, v126, v94
  v_mul_f32 v111, v111, v95
  v_mul_f32 v127, v127, v95
  v_mov_b32 v64, v96
  v_mov_b32 v65, v112
  v_fma_f32 v66, v34, v64, v97
  v_fma_f32 v67, v34, v65, v113
  v_fma_f32 v66, -v35, v65, v66
  v_fma_f32 v65, v35, v64, v67
  v_mov_b32 v64, v66

  v_fma_f32 v66, v34, v64, v98
  v_fma_f32 v67, v34, v65, v114
  v_fma_f32 v66, -v35, v65, v66
  v_fma_f32 v65, v35, v64, v67
  v_mov_b32 v64, v66

  v_fma_f32 v66, v34, v64, v99
  v_fma_f32 v67, v34, v65, v115
  v_fma_f32 v66, -v35, v65, v66
  v_fma_f32 v65, v35, v64, v67
  v_mov_b32 v64, v66

  v_fma_f32 v66, v34, v64, v100
  v_fma_f32 v67, v34, v65, v116
  v_fma_f32 v66, -v35, v65, v66
  v_fma_f32 v65, v35, v64, v67
  v_mov_b32 v64, v66

  v_fma_f32 v66, v34, v64, v101
  v_fma_f32 v67, v34, v65, v117
  v_fma_f32 v66, -v35, v65, v66
  v_fma_f32 v65, v35, v64, v67
  v_mov_b32 v64, v66

  v_fma_f32 v66, v34, v64, v102
  v_fma_f32 v67, v34, v65, v118
  v_fma_f32 v66, -v35, v65, v66
  v_fma_f32 v65, v35, v64, v67
  v_mov_b32 v64, v66

  v_fma_f32 v66, v34, v64, v103
  v_fma_f32 v67, v34, v65, v119
  v_fma_f32 v66, -v35, v65, v66
  v_fma_f32 v65, v35, v64, v67
  v_mov_b32 v64, v66

  v_fma_f32 v66, v34, v64, v104
  v_fma_f32 v67, v34, v65, v120
  v_fma_f32 v66, -v35, v65, v66
  v_fma_f32 v65, v35, v64, v67
  v_mov_b32 v64, v66

  v_fma_f32 v66, v34, v64, v105
  v_fma_f32 v67, v34, v65, v121
  v_fma_f32 v66, -v35, v65, v66
  v_fma_f32 v65, v35, v64, v67
  v_mov_b32 v64, v66

  v_fma_f32 v66, v34, v64, v106
  v_fma_f32 v67, v34, v65, v122
  v_fma_f32 v66, -v35, v65, v66
  v_fma_f32 v65, v35, v64, v67
  v_mov_b32 v64, v66

  v_fma_f32 v66, v34, v64, v107
  v_fma_f32 v67, v34, v65, v123
  v_fma_f32 v66, -v35, v65, v66
  v_fma_f32 v65, v35, v64, v67
  v_mov_b32 v64, v66

  v_fma_f32 v66, v34, v64, v108
  v_fma_f32 v67, v34, v65, v124
  v_fma_f32 v66, -v35, v65, v66
  v_fma_f32 v65, v35, v64, v67
  v_mov_b32 v64, v66

  v_fma_f32 v66, v34, v64, v109
  v_fma_f32 v67, v34, v65, v125
  v_fma_f32 v66, -v35, v65, v66
  v_fma_f32 v65, v35, v64, v67
  v_mov_b32 v64, v66

  v_fma_f32 v66, v34, v64, v110
  v_fma_f32 v67, v34, v65, v126
  v_fma_f32 v66, -v35, v65, v66
  v_fma_f32 v65, v35, v64, v67
  v_mov_b32 v64, v66

  v_fma_f32 v66, v34, v64, v111
  v_fma_f32 v67, v34, v65, v127
  v_fma_f32 v66, -v35, v65, v66
  v_fma_f32 v65, v35, v64, v67
  v_mov_b32 v64, v66

  s_lshl_b32 s5, s45, 9
  s_add_u32 s5, s5, 151680
  v_lshlrev_b32 v68, 8, v2
  v_lshl_add_u32 v68, v1, 3, v68
  v_add_u32 v68, s5, v68
  ds_write_b64 v68, v[64:65]

  v_mov_b32 v66, 0
  v_mov_b32 v67, 0
  v_mov_b32 v68, 0
  v_mov_b32 v69, 0
  v_mov_b32 v70, 0
  v_mov_b32 v71, 0
  v_mov_b32 v72, 0
  v_mov_b32 v73, 0
  v_mov_b32 v74, 0
  v_mov_b32 v75, 0
  v_mov_b32 v76, 0
  v_mov_b32 v77, 0
  v_mov_b32 v78, 0
  v_mov_b32 v79, 0
  v_mov_b32 v80, 0
  v_mov_b32 v81, 0
  v_mov_b32 v82, 0
  v_mov_b32 v83, 0
  v_mov_b32 v84, 0
  v_mov_b32 v85, 0
  v_mov_b32 v86, 0
  v_mov_b32 v87, 0
  v_mov_b32 v88, 0
  v_mov_b32 v89, 0
  v_mov_b32 v90, 0
  v_mov_b32 v91, 0
  v_mov_b32 v92, 0
  v_mov_b32 v93, 0
  v_mov_b32 v94, 0
  v_mov_b32 v95, 0
  s_waitcnt lgkmcnt(0)
  v_mov_b32 v64, 0
  v_mov_b32 v65, 0
  s_waitcnt vmcnt(6)
  s_barrier
  s_cmp_lg_u32 s44, 0
  s_cbranch_scc1 LB_nodgb
  s_lshl_b32 s5, s46, 7
  s_lshl_b32 s6, s47, 3
  s_add_u32 s5, s5, s6
  s_add_u32 s5, s5, 14829568
  v_mov_b32 v4, s96
  v_mov_b32 v5, s97
  v_mov_b32 v6, 0
  s_mov_b64 exec, 1
  buffer_store_dwordx2 v[4:5], v6, s[20:23], s5 offen sc1
  s_mov_b64 exec, -1

LB_nodgb:
  v_lshlrev_b32 v7, 3, v1
  v_add_u32 v7, 151680, v7
  v_mov_b32 v44, 0
  v_mov_b32 v45, 0

  s_cmp_lt_u32 s45, 1
  s_cbranch_scc1 LB_pref_done
  ds_read_b64 v[8:9], v7 offset:0
  ds_read_b64 v[10:11], v7 offset:256
  s_waitcnt lgkmcnt(0)
  v_fma_f32 v4, v36, v44, v8
  v_fma_f32 v5, v36, v45, v9
  v_fma_f32 v4, -v37, v45, v4
  v_fma_f32 v45, v37, v44, v5
  v_mov_b32 v44, v4

  v_fma_f32 v4, v36, v44, v10
  v_fma_f32 v5, v36, v45, v11
  v_fma_f32 v4, -v37, v45, v4
  v_fma_f32 v45, v37, v44, v5
  v_mov_b32 v44, v4

  s_cmp_lt_u32 s45, 2
  s_cbranch_scc1 LB_pref_done
  ds_read_b64 v[8:9], v7 offset:512
  ds_read_b64 v[10:11], v7 offset:768
  s_waitcnt lgkmcnt(0)
  v_fma_f32 v4, v36, v44, v8
  v_fma_f32 v5, v36, v45, v9
  v_fma_f32 v4, -v37, v45, v4
  v_fma_f32 v45, v37, v44, v5
  v_mov_b32 v44, v4

  v_fma_f32 v4, v36, v44, v10
  v_fma_f32 v5, v36, v45, v11
  v_fma_f32 v4, -v37, v45, v4
  v_fma_f32 v45, v37, v44, v5
  v_mov_b32 v44, v4

  s_cmp_lt_u32 s45, 3
  s_cbranch_scc1 LB_pref_done
  ds_read_b64 v[8:9], v7 offset:1024
  ds_read_b64 v[10:11], v7 offset:1280
  s_waitcnt lgkmcnt(0)
  v_fma_f32 v4, v36, v44, v8
  v_fma_f32 v5, v36, v45, v9
  v_fma_f32 v4, -v37, v45, v4
  v_fma_f32 v45, v37, v44, v5
  v_mov_b32 v44, v4

  v_fma_f32 v4, v36, v44, v10
  v_fma_f32 v5, v36, v45, v11
  v_fma_f32 v4, -v37, v45, v4
  v_fma_f32 v45, v37, v44, v5
  v_mov_b32 v44, v4

LB_pref_done:
  s_lshl_b32 s5, s45, 9
  v_add_u32 v7, s5, v7
  ds_read_b64 v[8:9], v7
  ds_read_b64 v[10:11], v7 offset:256
  s_waitcnt lgkmcnt(0)

  v_fma_f32 v4, v36, v44, v8
  v_fma_f32 v5, v36, v45, v9
  v_fma_f32 v4, -v37, v45, v4
  v_fma_f32 v7, v37, v44, v5
  v_mov_b32 v6, v4

  v_fma_f32 v4, v36, v6, v10
  v_fma_f32 v5, v36, v7, v11
  v_fma_f32 v4, -v37, v7, v4
  v_fma_f32 v14, v37, v6, v5
  v_mov_b32 v12, v4

  v_cmp_gt_u32 vcc, 32, v0
  s_nop 1
  v_cndmask_b32 v44, v6, v44, vcc
  v_cndmask_b32 v45, v7, v45, vcc
  s_cmp_lg_u32 s45, 3
  s_cbranch_scc1 LB_nopub
  s_cmp_eq_u32 s46, 15
  s_cbranch_scc1 LB_nopub
  s_lshl_b32 s5, s46, 13
  s_lshl_b32 s6, s47, 9
  s_add_u32 s5, s5, s6
  v_lshlrev_b32 v7, 4, v1
  v_mov_b32 v13, s96
  v_mov_b32 v15, s97
  s_mov_b32 exec_hi, 0
  buffer_store_dwordx4 v[12:15], v7, s[28:31], s5 offen sc1
  s_mov_b32 exec_hi, -1

LB_nopub:
  s_mul_i32 s5, s45, 56
  v_add_u32 v7, s5, v0
  v_lshlrev_b32 v7, 6, v7
  s_mul_i32 s5, s47, 14336
  s_add_u32 s5, s5, 131072

  buffer_load_dwordx4 v[48:51], v7, s[28:31], s5 offen offset:0 sc1
  buffer_load_dwordx4 v[52:55], v7, s[28:31], s5 offen offset:16 sc1
  buffer_load_dwordx4 v[56:59], v7, s[28:31], s5 offen offset:32 sc1
  buffer_load_dwordx4 v[60:63], v7, s[28:31], s5 offen offset:48 sc1
  v_add_u32 v47, 122880, v46
  ds_read_b64_tr_b16 v[16:17], v47 offset:0
  ds_read_b64_tr_b16 v[18:19], v47 offset:896
  ds_read_b64_tr_b16 v[20:21], v47 offset:32
  ds_read_b64_tr_b16 v[22:23], v47 offset:928
  ds_read_b64_tr_b16 v[24:25], v47 offset:3584
  ds_read_b64_tr_b16 v[26:27], v47 offset:4480
  s_waitcnt lgkmcnt(4)
  v_mfma_f32_32x32x16_bf16 v[64:79], v[16:19], a[0:3], v[64:79]
  ds_read_b64_tr_b16 v[16:17], v47 offset:3616
  ds_read_b64_tr_b16 v[18:19], v47 offset:4512
  s_waitcnt lgkmcnt(4)
  v_mfma_f32_32x32x16_bf16 v[80:95], v[20:23], a[0:3], v[80:95]
  ds_read_b64_tr_b16 v[20:21], v47 offset:7168
  ds_read_b64_tr_b16 v[22:23], v47 offset:8064
  s_waitcnt lgkmcnt(4)
  v_mfma_f32_32x32x16_bf16 v[64:79], v[24:27], a[4:7], v[64:79]
  ds_read_b64_tr_b16 v[24:25], v47 offset:7200
  ds_read_b64_tr_b16 v[26:27], v47 offset:8096
  s_waitcnt lgkmcnt(4)
  v_mfma_f32_32x32x16_bf16 v[80:95], v[16:19], a[4:7], v[80:95]
  ds_read_b64_tr_b16 v[16:17], v47 offset:10752
  ds_read_b64_tr_b16 v[18:19], v47 offset:11648
  s_waitcnt lgkmcnt(4)
  v_mfma_f32_32x32x16_bf16 v[64:79], v[20:23], a[8:11], v[64:79]
  ds_read_b64_tr_b16 v[20:21], v47 offset:10784
  ds_read_b64_tr_b16 v[22:23], v47 offset:11680
  s_waitcnt lgkmcnt(4)
  v_mfma_f32_32x32x16_bf16 v[80:95], v[24:27], a[8:11], v[80:95]
  v_add_u32 v47, 86400, v46
  ds_read_b64_tr_b16 v[24:25], v47 offset:0
  ds_read_b64_tr_b16 v[26:27], v47 offset:896
  s_waitcnt lgkmcnt(4)
  v_mfma_f32_32x32x16_bf16 v[64:79], v[16:19], a[12:15], v[64:79]
  ds_read_b64_tr_b16 v[16:17], v47 offset:32
  ds_read_b64_tr_b16 v[18:19], v47 offset:928
  s_waitcnt lgkmcnt(4)
  v_mfma_f32_32x32x16_bf16 v[80:95], v[20:23], a[12:15], v[80:95]
  s_waitcnt vmcnt(7)
  s_barrier
  ds_read_b64_tr_b16 v[20:21], v47 offset:3584
  ds_read_b64_tr_b16 v[22:23], v47 offset:4480
  s_waitcnt lgkmcnt(4)
  v_mfma_f32_32x32x16_bf16 v[64:79], v[24:27], a[16:19], v[64:79]
  s_add_u32 m0, s59, 122880
  s_nop 0
  buffer_load_dwordx4 v28, s[16:19], s77 offen lds
  ds_read_b64_tr_b16 v[24:25], v47 offset:3616
  ds_read_b64_tr_b16 v[26:27], v47 offset:4512
  s_waitcnt lgkmcnt(4)
  v_mfma_f32_32x32x16_bf16 v[80:95], v[16:19], a[16:19], v[80:95]
  s_add_u32 m0, s59, 123904
  s_nop 0
  buffer_load_dwordx4 v29, s[16:19], s77 offen lds
  ds_read_b64_tr_b16 v[16:17], v47 offset:7168
  ds_read_b64_tr_b16 v[18:19], v47 offset:8064
  s_waitcnt lgkmcnt(4)
  v_mfma_f32_32x32x16_bf16 v[64:79], v[20:23], a[20:23], v[64:79]
  s_add_u32 m0, s59, 124928
  s_nop 0
  buffer_load_dwordx4 v30, s[16:19], s77 offen lds
  ds_read_b64_tr_b16 v[20:21], v47 offset:7200
  ds_read_b64_tr_b16 v[22:23], v47 offset:8096
  s_waitcnt lgkmcnt(4)
  v_mfma_f32_32x32x16_bf16 v[80:95], v[24:27], a[20:23], v[80:95]
  ds_read_b64_tr_b16 v[24:25], v47 offset:10752
  ds_read_b64_tr_b16 v[26:27], v47 offset:11648
  s_waitcnt lgkmcnt(4)
  v_mfma_f32_32x32x16_bf16 v[64:79], v[16:19], a[24:27], v[64:79]
  ds_read_b64_tr_b16 v[16:17], v47 offset:10784
  ds_read_b64_tr_b16 v[18:19], v47 offset:11680
  s_waitcnt lgkmcnt(4)
  v_mfma_f32_32x32x16_bf16 v[80:95], v[20:23], a[24:27], v[80:95]
  v_add_u32 v47, 0, v46
  ds_read_b64_tr_b16 v[20:21], v47 offset:0
  ds_read_b64_tr_b16 v[22:23], v47 offset:896
  s_waitcnt lgkmcnt(4)
  v_mfma_f32_32x32x16_bf16 v[64:79], v[24:27], a[28:31], v[64:79]
  ds_read_b64_tr_b16 v[24:25], v47 offset:32
  ds_read_b64_tr_b16 v[26:27], v47 offset:928
  s_waitcnt lgkmcnt(4)
  v_mfma_f32_32x32x16_bf16 v[80:95], v[16:19], a[28:31], v[80:95]
  s_waitcnt vmcnt(7)
  s_barrier
  s_waitcnt vmcnt(3)
LB_csretry:
  v_xor_b32 v4, s96, v49
  v_xor_b32 v5, s96, v51
  v_or_b32 v4, v4, v5
  v_xor_b32 v5, s96, v53
  v_or_b32 v4, v4, v5
  v_xor_b32 v5, s96, v55
  v_or_b32 v4, v4, v5
  v_xor_b32 v5, s96, v57
  v_or_b32 v4, v4, v5
  v_xor_b32 v5, s96, v59
  v_or_b32 v4, v4, v5
  v_xor_b32 v5, s96, v61
  v_or_b32 v4, v4, v5
  v_xor_b32 v5, s96, v63
  v_or_b32 v4, v4, v5
  v_cmp_gt_u32 s[6:7], 56, v0
  v_cmp_ne_u32 vcc, 0, v4
  s_nop 1
  s_and_b64 vcc, vcc, s[6:7]
  s_cmp_eq_u64 vcc, 0
  s_cbranch_scc1 LB_csok
  s_add_u32 s43, s43, 1
  s_cmp_gt_u32 s43, 0x20000
  s_cbranch_scc1 LB_csok
  s_sleep 1

  s_mul_i32 s5, s45, 56
  v_add_u32 v7, s5, v0
  v_lshlrev_b32 v7, 6, v7
  s_mul_i32 s5, s47, 14336
  s_add_u32 s5, s5, 131072

  buffer_load_dwordx4 v[48:51], v7, s[28:31], s5 offen offset:0 sc1
  buffer_load_dwordx4 v[52:55], v7, s[28:31], s5 offen offset:16 sc1
  buffer_load_dwordx4 v[56:59], v7, s[28:31], s5 offen offset:32 sc1
  buffer_load_dwordx4 v[60:63], v7, s[28:31], s5 offen offset:48 sc1
  s_waitcnt vmcnt(0)
  s_branch LB_csretry
LB_csok:
  v_add_f32 v48, v48, v50
  v_add_f32 v52, v52, v54
  v_add_f32 v56, v56, v58
  v_add_f32 v60, v60, v62
  v_add_f32 v48, v48, v52
  v_add_f32 v56, v56, v60
  v_add_f32 v48, v48, v56
  s_mul_i32 s5, s45, 56
  v_add_u32 v7, s5, v0
  v_lshlrev_b32 v7, 2, v7
  v_add_u32 v7, 159872, v7
  s_mov_b64 exec, s[6:7]
  ds_write_b32 v7, v48
  s_mov_b64 exec, -1
  s_waitcnt lgkmcnt(0)

  s_sub_u32 s5, s46, 15
  s_lshl_b32 s5, s5, 13
  s_lshl_b32 s6, s47, 9
  s_add_u32 s5, s5, s6
  v_lshlrev_b32 v7, 13, v2
  v_sub_u32 v7, s5, v7
  v_lshl_add_u32 v7, v1, 4, v7

  buffer_load_dwordx4 v[48:51], v7, s[28:31], 0 offen sc1
  v_add_u32 v7, 16384, v7
  buffer_load_dwordx4 v[52:55], v7, s[28:31], 0 offen sc1
  v_add_u32 v7, 16384, v7
  buffer_load_dwordx4 v[56:59], v7, s[28:31], 0 offen sc1
  v_add_u32 v7, 16384, v7
  buffer_load_dwordx4 v[60:63], v7, s[28:31], 0 offen sc1
  ds_read_b64_tr_b16 v[16:17], v47 offset:3584
  ds_read_b64_tr_b16 v[18:19], v47 offset:4480
  s_waitcnt lgkmcnt(4)
  v_mfma_f32_32x32x16_bf16 v[64:79], v[20:23], a[32:35], v[64:79]
  s_add_u32 m0, s59, 86400
  s_nop 0
  buffer_load_dwordx4 v28, s[16:19], s78 offen lds
  ds_read_b64_tr_b16 v[20:21], v47 offset:3616
  ds_read_b64_tr_b16 v[22:23], v47 offset:4512
  s_waitcnt lgkmcnt(4)
  v_mfma_f32_32x32x16_bf16 v[80:95], v[24:27], a[32:35], v[80:95]
  s_add_u32 m0, s59, 87424
  s_nop 0
  buffer_load_dwordx4 v29, s[16:19], s78 offen lds
  ds_read_b64_tr_b16 v[24:25], v47 offset:7168
  ds_read_b64_tr_b16 v[26:27], v47 offset:8064
  s_waitcnt lgkmcnt(4)
  v_mfma_f32_32x32x16_bf16 v[64:79], v[16:19], a[36:39], v[64:79]
  s_add_u32 m0, s59, 88448
  s_nop 0
  buffer_load_dwordx4 v30, s[16:19], s78 offen lds
  ds_read_b64_tr_b16 v[16:17], v47 offset:7200
  ds_read_b64_tr_b16 v[18:19], v47 offset:8096
  s_waitcnt lgkmcnt(4)
  v_mfma_f32_32x32x16_bf16 v[80:95], v[20:23], a[36:39], v[80:95]
  ds_read_b64_tr_b16 v[20:21], v47 offset:10752
  ds_read_b64_tr_b16 v[22:23], v47 offset:11648
  s_waitcnt lgkmcnt(4)
  v_mfma_f32_32x32x16_bf16 v[64:79], v[24:27], a[40:43], v[64:79]
  ds_read_b64_tr_b16 v[24:25], v47 offset:10784
  ds_read_b64_tr_b16 v[26:27], v47 offset:11680
  s_waitcnt lgkmcnt(4)
  v_mfma_f32_32x32x16_bf16 v[80:95], v[16:19], a[40:43], v[80:95]
  v_add_u32 v47, 28800, v46
  ds_read_b64_tr_b16 v[16:17], v47 offset:0
  ds_read_b64_tr_b16 v[18:19], v47 offset:896
  s_waitcnt lgkmcnt(4)
  v_mfma_f32_32x32x16_bf16 v[64:79], v[20:23], a[44:47], v[64:79]
  ds_read_b64_tr_b16 v[20:21], v47 offset:32
  ds_read_b64_tr_b16 v[22:23], v47 offset:928
  s_waitcnt lgkmcnt(4)
  v_mfma_f32_32x32x16_bf16 v[80:95], v[24:27], a[44:47], v[80:95]
  s_waitcnt vmcnt(7)
  s_barrier
  s_and_b32 s5, s2, 1
  s_lshl_b32 s5, s5, 2
  s_lshr_b32 s6, s2, 6
  s_add_u32 s5, s5, s6
  s_lshl_b32 s5, s5, 1
  v_bfe_u32 v7, v0, 4, 1
  v_add_u32 v7, s5, v7
  v_lshlrev_b32 v7, 7, v7
  v_and_b32 v6, 15, v0
  v_lshl_add_u32 v7, v6, 3, v7
  s_mov_b32 s5, 14829568

  buffer_load_dwordx2 v[12:13], v7, s[20:23], s5 offen sc1
  ds_read_b64_tr_b16 v[24:25], v47 offset:3584
  ds_read_b64_tr_b16 v[26:27], v47 offset:4480
  s_waitcnt lgkmcnt(4)
  v_mfma_f32_32x32x16_bf16 v[64:79], v[16:19], a[48:51], v[64:79]
  s_add_u32 m0, s59, 0
  s_nop 0
  buffer_load_dwordx4 v28, s[16:19], s79 offen lds
  ds_read_b64_tr_b16 v[16:17], v47 offset:3616
  ds_read_b64_tr_b16 v[18:19], v47 offset:4512
  s_waitcnt lgkmcnt(4)
  v_mfma_f32_32x32x16_bf16 v[80:95], v[20:23], a[48:51], v[80:95]
  s_add_u32 m0, s59, 1024
  s_nop 0
  buffer_load_dwordx4 v29, s[16:19], s79 offen lds
  ds_read_b64_tr_b16 v[20:21], v47 offset:7168
  ds_read_b64_tr_b16 v[22:23], v47 offset:8064
  s_waitcnt lgkmcnt(4)
  v_mfma_f32_32x32x16_bf16 v[64:79], v[24:27], a[52:55], v[64:79]
  s_add_u32 m0, s59, 2048
  s_nop 0
  buffer_load_dwordx4 v30, s[16:19], s79 offen lds
  ds_read_b64_tr_b16 v[24:25], v47 offset:7200
  ds_read_b64_tr_b16 v[26:27], v47 offset:8096
  s_waitcnt lgkmcnt(4)
  v_mfma_f32_32x32x16_bf16 v[80:95], v[16:19], a[52:55], v[80:95]
  ds_read_b64_tr_b16 v[16:17], v47 offset:10752
  ds_read_b64_tr_b16 v[18:19], v47 offset:11648
  s_waitcnt lgkmcnt(4)
  v_mfma_f32_32x32x16_bf16 v[64:79], v[20:23], a[56:59], v[64:79]
  ds_read_b64_tr_b16 v[20:21], v47 offset:10784
  ds_read_b64_tr_b16 v[22:23], v47 offset:11680
  s_waitcnt lgkmcnt(4)
  v_mfma_f32_32x32x16_bf16 v[80:95], v[24:27], a[56:59], v[80:95]
  v_add_u32 v47, 57600, v46
  ds_read_b64_tr_b16 v[24:25], v47 offset:0
  ds_read_b64_tr_b16 v[26:27], v47 offset:896
  s_waitcnt lgkmcnt(4)
  v_mfma_f32_32x32x16_bf16 v[64:79], v[16:19], a[60:63], v[64:79]
  ds_read_b64_tr_b16 v[16:17], v47 offset:32
  ds_read_b64_tr_b16 v[18:19], v47 offset:928
  s_waitcnt lgkmcnt(4)
  v_mfma_f32_32x32x16_bf16 v[80:95], v[20:23], a[60:63], v[80:95]
  s_waitcnt vmcnt(4)
  s_barrier
  s_waitcnt vmcnt(3)
  v_xor_b32 v12, s96, v12
  v_xor_b32 v13, s97, v13
  v_or_b32 v12, v12, v13
  v_cmp_ne_u32 vcc, 0, v12
  s_nop 1
  s_cmp_eq_u64 vcc, 0
  s_cselect_b32 s98, 1, 0
  s_cmp_lg_u32 s44, 0
  s_cbranch_scc1 LB_nodgbf
  v_mov_b32 v12, s98
  v_mov_b32 v13, 160912
  ds_write_b32 v13, v12
  s_waitcnt lgkmcnt(0)

LB_nodgbf:
LB_eretry0:
  v_mov_b32 v4, 0
  v_add_u32 v5, 15, v2
  v_cmp_ge_u32 vcc, s46, v5
  v_mov_b32 v5, s96
  v_mov_b32 v6, s97
  v_cndmask_b32 v5, 0, v5, vcc
  v_cndmask_b32 v6, 0, v6, vcc
  v_xor_b32 v5, v5, v49
  v_xor_b32 v6, v6, v51
  v_or3_b32 v4, v4, v5, v6

  v_add_u32 v5, 13, v2
  v_cmp_ge_u32 vcc, s46, v5
  v_mov_b32 v5, s96
  v_mov_b32 v6, s97
  v_cndmask_b32 v5, 0, v5, vcc
  v_cndmask_b32 v6, 0, v6, vcc
  v_xor_b32 v5, v5, v53
  v_xor_b32 v6, v6, v55
  v_or3_b32 v4, v4, v5, v6

  v_add_u32 v5, 11, v2
  v_cmp_ge_u32 vcc, s46, v5
  v_mov_b32 v5, s96
  v_mov_b32 v6, s97
  v_cndmask_b32 v5, 0, v5, vcc
  v_cndmask_b32 v6, 0, v6, vcc
  v_xor_b32 v5, v5, v57
  v_xor_b32 v6, v6, v59
  v_or3_b32 v4, v4, v5, v6

  v_add_u32 v5, 9, v2
  v_cmp_ge_u32 vcc, s46, v5
  v_mov_b32 v5, s96
  v_mov_b32 v6, s97
  v_cndmask_b32 v5, 0, v5, vcc
  v_cndmask_b32 v6, 0, v6, vcc
  v_xor_b32 v5, v5, v61
  v_xor_b32 v6, v6, v63
  v_or3_b32 v4, v4, v5, v6

  v_cmp_ne_u32 vcc, 0, v4
  s_nop 1
  s_cmp_eq_u64 vcc, 0
  s_cbranch_scc1 LB_eok0
  s_add_u32 s43, s43, 1
  s_cmp_gt_u32 s43, 0x20000
  s_cbranch_scc1 LB_eok0
  s_sleep 1

  s_sub_u32 s5, s46, 15
  s_lshl_b32 s5, s5, 13
  s_lshl_b32 s6, s47, 9
  s_add_u32 s5, s5, s6
  v_lshlrev_b32 v7, 13, v2
  v_sub_u32 v7, s5, v7
  v_lshl_add_u32 v7, v1, 4, v7

  buffer_load_dwordx4 v[48:51], v7, s[28:31], 0 offen sc1
  v_add_u32 v7, 16384, v7
  buffer_load_dwordx4 v[52:55], v7, s[28:31], 0 offen sc1
  v_add_u32 v7, 16384, v7
  buffer_load_dwordx4 v[56:59], v7, s[28:31], 0 offen sc1
  v_add_u32 v7, 16384, v7
  buffer_load_dwordx4 v[60:63], v7, s[28:31], 0 offen sc1
  s_waitcnt vmcnt(0)
  s_branch LB_eretry0
LB_eok0:
  v_mul_f32 v4, v38, v38
  v_mul_f32 v5, v38, v39
  v_fma_f32 v4, -v39, v39, v4
  v_fma_f32 v5, v39, v38, v5
  v_mov_b32 v8, v4
  v_mov_b32 v9, v5

  v_mov_b32 v10, 0
  v_mov_b32 v11, 0
  v_fma_f32 v4, v8, v10, v48
  v_fma_f32 v5, v8, v11, v50
  v_fma_f32 v4, -v9, v11, v4
  v_fma_f32 v11, v9, v10, v5
  v_mov_b32 v10, v4

  v_fma_f32 v4, v8, v10, v52
  v_fma_f32 v5, v8, v11, v54
  v_fma_f32 v4, -v9, v11, v4
  v_fma_f32 v11, v9, v10, v5
  v_mov_b32 v10, v4

  v_fma_f32 v4, v8, v10, v56
  v_fma_f32 v5, v8, v11, v58
  v_fma_f32 v4, -v9, v11, v4
  v_fma_f32 v11, v9, v10, v5
  v_mov_b32 v10, v4

  v_fma_f32 v4, v8, v10, v60
  v_fma_f32 v5, v8, v11, v62
  v_fma_f32 v4, -v9, v11, v4
  v_fma_f32 v11, v9, v10, v5
  v_mov_b32 v10, v4

  s_sub_u32 s5, s46, 7
  s_lshl_b32 s5, s5, 13
  s_lshl_b32 s6, s47, 9
  s_add_u32 s5, s5, s6
  v_lshlrev_b32 v7, 13, v2
  v_sub_u32 v7, s5, v7
  v_lshl_add_u32 v7, v1, 4, v7

  buffer_load_dwordx4 v[48:51], v7, s[28:31], 0 offen sc1
  v_add_u32 v7, 16384, v7
  buffer_load_dwordx4 v[52:55], v7, s[28:31], 0 offen sc1
  v_add_u32 v7, 16384, v7
  buffer_load_dwordx4 v[56:59], v7, s[28:31], 0 offen sc1
  v_add_u32 v7, 16384, v7
  buffer_load_dwordx4 v[60:63], v7, s[28:31], 0 offen sc1
  ds_read_b64_tr_b16 v[20:21], v47 offset:3584
  ds_read_b64_tr_b16 v[22:23], v47 offset:4480
  s_waitcnt lgkmcnt(4)
  v_mfma_f32_32x32x16_bf16 v[64:79], v[24:27], a[64:67], v[64:79]
  ds_read_b64_tr_b16 v[24:25], v47 offset:3616
  ds_read_b64_tr_b16 v[26:27], v47 offset:4512
  s_waitcnt lgkmcnt(4)
  v_mfma_f32_32x32x16_bf16 v[80:95], v[16:19], a[64:67], v[80:95]
  ds_read_b64_tr_b16 v[16:17], v47 offset:7168
  ds_read_b64_tr_b16 v[18:19], v47 offset:8064
  s_waitcnt lgkmcnt(4)
  v_mfma_f32_32x32x16_bf16 v[64:79], v[20:23], a[68:71], v[64:79]
  ds_read_b64_tr_b16 v[20:21], v47 offset:7200
  ds_read_b64_tr_b16 v[22:23], v47 offset:8096
  s_waitcnt lgkmcnt(4)
  v_mfma_f32_32x32x16_bf16 v[80:95], v[24:27], a[68:71], v[80:95]
  ds_read_b64_tr_b16 v[24:25], v47 offset:10752
  ds_read_b64_tr_b16 v[26:27], v47 offset:11648
  s_waitcnt lgkmcnt(4)
  v_mfma_f32_32x32x16_bf16 v[64:79], v[16:19], a[72:75], v[64:79]
  ds_read_b64_tr_b16 v[16:17], v47 offset:10784
  ds_read_b64_tr_b16 v[18:19], v47 offset:11680
  s_waitcnt lgkmcnt(4)
  v_mfma_f32_32x32x16_bf16 v[80:95], v[20:23], a[72:75], v[80:95]
  v_add_u32 v47, 122880, v46
  ds_read_b64_tr_b16 v[20:21], v47 offset:0
  ds_read_b64_tr_b16 v[22:23], v47 offset:896
  s_waitcnt lgkmcnt(4)
  v_mfma_f32_32x32x16_bf16 v[64:79], v[24:27], a[76:79], v[64:79]
  ds_read_b64_tr_b16 v[24:25], v47 offset:32
  ds_read_b64_tr_b16 v[26:27], v47 offset:928
  s_waitcnt lgkmcnt(4)
  v_mfma_f32_32x32x16_bf16 v[80:95], v[16:19], a[76:79], v[80:95]
  s_waitcnt vmcnt(4)
  s_barrier
  s_waitcnt vmcnt(0)
LB_eretry1:
  v_mov_b32 v4, 0
  v_add_u32 v5, 7, v2
  v_cmp_ge_u32 vcc, s46, v5
  v_mov_b32 v5, s96
  v_mov_b32 v6, s97
  v_cndmask_b32 v5, 0, v5, vcc
  v_cndmask_b32 v6, 0, v6, vcc
  v_xor_b32 v5, v5, v49
  v_xor_b32 v6, v6, v51
  v_or3_b32 v4, v4, v5, v6

  v_add_u32 v5, 5, v2
  v_cmp_ge_u32 vcc, s46, v5
  v_mov_b32 v5, s96
  v_mov_b32 v6, s97
  v_cndmask_b32 v5, 0, v5, vcc
  v_cndmask_b32 v6, 0, v6, vcc
  v_xor_b32 v5, v5, v53
  v_xor_b32 v6, v6, v55
  v_or3_b32 v4, v4, v5, v6

  v_add_u32 v5, 3, v2
  v_cmp_ge_u32 vcc, s46, v5
  v_mov_b32 v5, s96
  v_mov_b32 v6, s97
  v_cndmask_b32 v5, 0, v5, vcc
  v_cndmask_b32 v6, 0, v6, vcc
  v_xor_b32 v5, v5, v57
  v_xor_b32 v6, v6, v59
  v_or3_b32 v4, v4, v5, v6

  v_add_u32 v5, 1, v2
  v_cmp_ge_u32 vcc, s46, v5
  v_mov_b32 v5, s96
  v_mov_b32 v6, s97
  v_cndmask_b32 v5, 0, v5, vcc
  v_cndmask_b32 v6, 0, v6, vcc
  v_xor_b32 v5, v5, v61
  v_xor_b32 v6, v6, v63
  v_or3_b32 v4, v4, v5, v6

  v_cmp_ne_u32 vcc, 0, v4
  s_nop 1
  s_cmp_eq_u64 vcc, 0
  s_cbranch_scc1 LB_eok1
  s_add_u32 s43, s43, 1
  s_cmp_gt_u32 s43, 0x20000
  s_cbranch_scc1 LB_eok1
  s_sleep 1

  s_sub_u32 s5, s46, 7
  s_lshl_b32 s5, s5, 13
  s_lshl_b32 s6, s47, 9
  s_add_u32 s5, s5, s6
  v_lshlrev_b32 v7, 13, v2
  v_sub_u32 v7, s5, v7
  v_lshl_add_u32 v7, v1, 4, v7

  buffer_load_dwordx4 v[48:51], v7, s[28:31], 0 offen sc1
  v_add_u32 v7, 16384, v7
  buffer_load_dwordx4 v[52:55], v7, s[28:31], 0 offen sc1
  v_add_u32 v7, 16384, v7
  buffer_load_dwordx4 v[56:59], v7, s[28:31], 0 offen sc1
  v_add_u32 v7, 16384, v7
  buffer_load_dwordx4 v[60:63], v7, s[28:31], 0 offen sc1
  s_waitcnt vmcnt(0)
  s_branch LB_eretry1
LB_eok1:
  v_fma_f32 v4, v8, v10, v48
  v_fma_f32 v5, v8, v11, v50
  v_fma_f32 v4, -v9, v11, v4
  v_fma_f32 v11, v9, v10, v5
  v_mov_b32 v10, v4

  v_fma_f32 v4, v8, v10, v52
  v_fma_f32 v5, v8, v11, v54
  v_fma_f32 v4, -v9, v11, v4
  v_fma_f32 v11, v9, v10, v5
  v_mov_b32 v10, v4

  v_fma_f32 v4, v8, v10, v56
  v_fma_f32 v5, v8, v11, v58
  v_fma_f32 v4, -v9, v11, v4
  v_fma_f32 v11, v9, v10, v5
  v_mov_b32 v10, v4

  v_fma_f32 v4, v8, v10, v60
  v_fma_f32 v5, v8, v11, v62
  v_fma_f32 v4, -v9, v11, v4
  v_fma_f32 v11, v9, v10, v5
  v_mov_b32 v10, v4

  v_mul_f32 v4, v38, v10
  v_mul_f32 v5, v38, v11
  v_fma_f32 v4, -v39, v11, v4
  v_fma_f32 v5, v39, v10, v5
  v_mov_b32 v6, v4
  v_mov_b32 v7, v5

  v_cmp_gt_u32 vcc, 32, v0
  s_nop 1
  v_cndmask_b32 v10, v6, v10, vcc
  v_cndmask_b32 v11, v7, v11, vcc
  v_mov_b32 v6, v10
  v_mov_b32 v7, v11
  s_nop 1
  v_permlane32_swap_b32 v10, v6
  v_permlane32_swap_b32 v11, v7
  s_nop 1
  v_add_f32 v10, v10, v6
  v_add_f32 v11, v11, v7

  v_fma_f32 v4, v42, v10, v44
  v_fma_f32 v5, v42, v11, v45
  v_fma_f32 v4, -v43, v11, v4
  v_fma_f32 v45, v43, v10, v5
  v_mov_b32 v44, v4

  v_fma_f32 v4, v34, v44, v96
  v_fma_f32 v5, v34, v45, v112
  v_fma_f32 v4, -v35, v45, v4
  v_fma_f32 v45, v35, v44, v5
  v_mov_b32 v44, v4

  v_mul_f32 v96, v40, v44
  v_mul_f32 v112, -v40, v45
  v_fma_f32 v96, -v41, v45, v96
  v_fma_f32 v112, -v41, v44, v112

  v_fma_f32 v4, v34, v44, v97
  v_fma_f32 v5, v34, v45, v113
  v_fma_f32 v4, -v35, v45, v4
  v_fma_f32 v45, v35, v44, v5
  v_mov_b32 v44, v4

  v_mul_f32 v97, v40, v44
  v_mul_f32 v113, -v40, v45
  v_fma_f32 v97, -v41, v45, v97
  v_fma_f32 v113, -v41, v44, v113

  v_fma_f32 v4, v34, v44, v98
  v_fma_f32 v5, v34, v45, v114
  v_fma_f32 v4, -v35, v45, v4
  v_fma_f32 v45, v35, v44, v5
  v_mov_b32 v44, v4

  v_mul_f32 v98, v40, v44
  v_mul_f32 v114, -v40, v45
  v_fma_f32 v98, -v41, v45, v98
  v_fma_f32 v114, -v41, v44, v114

  v_fma_f32 v4, v34, v44, v99
  v_fma_f32 v5, v34, v45, v115
  v_fma_f32 v4, -v35, v45, v4
  v_fma_f32 v45, v35, v44, v5
  v_mov_b32 v44, v4

  v_mul_f32 v99, v40, v44
  v_mul_f32 v115, -v40, v45
  v_fma_f32 v99, -v41, v45, v99
  v_fma_f32 v115, -v41, v44, v115

  v_fma_f32 v4, v34, v44, v100
  v_fma_f32 v5, v34, v45, v116
  v_fma_f32 v4, -v35, v45, v4
  v_fma_f32 v45, v35, v44, v5
  v_mov_b32 v44, v4

  v_mul_f32 v100, v40, v44
  v_mul_f32 v116, -v40, v45
  v_fma_f32 v100, -v41, v45, v100
  v_fma_f32 v116, -v41, v44, v116

  v_fma_f32 v4, v34, v44, v101
  v_fma_f32 v5, v34, v45, v117
  v_fma_f32 v4, -v35, v45, v4
  v_fma_f32 v45, v35, v44, v5
  v_mov_b32 v44, v4

  v_mul_f32 v101, v40, v44
  v_mul_f32 v117, -v40, v45
  v_fma_f32 v101, -v41, v45, v101
  v_fma_f32 v117, -v41, v44, v117

  v_fma_f32 v4, v34, v44, v102
  v_fma_f32 v5, v34, v45, v118
  v_fma_f32 v4, -v35, v45, v4
  v_fma_f32 v45, v35, v44, v5
  v_mov_b32 v44, v4

  v_mul_f32 v102, v40, v44
  v_mul_f32 v118, -v40, v45
  v_fma_f32 v102, -v41, v45, v102
  v_fma_f32 v118, -v41, v44, v118

  v_fma_f32 v4, v34, v44, v103
  v_fma_f32 v5, v34, v45, v119
  v_fma_f32 v4, -v35, v45, v4
  v_fma_f32 v45, v35, v44, v5
  v_mov_b32 v44, v4

  v_mul_f32 v103, v40, v44
  v_mul_f32 v119, -v40, v45
  v_fma_f32 v103, -v41, v45, v103
  v_fma_f32 v119, -v41, v44, v119

  v_fma_f32 v4, v34, v44, v104
  v_fma_f32 v5, v34, v45, v120
  v_fma_f32 v4, -v35, v45, v4
  v_fma_f32 v45, v35, v44, v5
  v_mov_b32 v44, v4

  v_mul_f32 v104, v40, v44
  v_mul_f32 v120, -v40, v45
  v_fma_f32 v104, -v41, v45, v104
  v_fma_f32 v120, -v41, v44, v120

  v_fma_f32 v4, v34, v44, v105
  v_fma_f32 v5, v34, v45, v121
  v_fma_f32 v4, -v35, v45, v4
  v_fma_f32 v45, v35, v44, v5
  v_mov_b32 v44, v4

  v_mul_f32 v105, v40, v44
  v_mul_f32 v121, -v40, v45
  v_fma_f32 v105, -v41, v45, v105
  v_fma_f32 v121, -v41, v44, v121

  v_fma_f32 v4, v34, v44, v106
  v_fma_f32 v5, v34, v45, v122
  v_fma_f32 v4, -v35, v45, v4
  v_fma_f32 v45, v35, v44, v5
  v_mov_b32 v44, v4

  v_mul_f32 v106, v40, v44
  v_mul_f32 v122, -v40, v45
  v_fma_f32 v106, -v41, v45, v106
  v_fma_f32 v122, -v41, v44, v122

  v_fma_f32 v4, v34, v44, v107
  v_fma_f32 v5, v34, v45, v123
  v_fma_f32 v4, -v35, v45, v4
  v_fma_f32 v45, v35, v44, v5
  v_mov_b32 v44, v4

  v_mul_f32 v107, v40, v44
  v_mul_f32 v123, -v40, v45
  v_fma_f32 v107, -v41, v45, v107
  v_fma_f32 v123, -v41, v44, v123

  v_fma_f32 v4, v34, v44, v108
  v_fma_f32 v5, v34, v45, v124
  v_fma_f32 v4, -v35, v45, v4
  v_fma_f32 v45, v35, v44, v5
  v_mov_b32 v44, v4

  v_mul_f32 v108, v40, v44
  v_mul_f32 v124, -v40, v45
  v_fma_f32 v108, -v41, v45, v108
  v_fma_f32 v124, -v41, v44, v124

  v_fma_f32 v4, v34, v44, v109
  v_fma_f32 v5, v34, v45, v125
  v_fma_f32 v4, -v35, v45, v4
  v_fma_f32 v45, v35, v44, v5
  v_mov_b32 v44, v4

  v_mul_f32 v109, v40, v44
  v_mul_f32 v125, -v40, v45
  v_fma_f32 v109, -v41, v45, v109
  v_fma_f32 v125, -v41, v44, v125

  v_fma_f32 v4, v34, v44, v110
  v_fma_f32 v5, v34, v45, v126
  v_fma_f32 v4, -v35, v45, v4
  v_fma_f32 v45, v35, v44, v5
  v_mov_b32 v44, v4

  v_mul_f32 v110, v40, v44
  v_mul_f32 v126, -v40, v45
  v_fma_f32 v110, -v41, v45, v110
  v_fma_f32 v126, -v41, v44, v126

  v_fma_f32 v4, v34, v44, v111
  v_fma_f32 v5, v34, v45, v127
  v_fma_f32 v4, -v35, v45, v4
  v_fma_f32 v45, v35, v44, v5
  v_mov_b32 v44, v4

  v_mul_f32 v111, v40, v44
  v_mul_f32 v127, -v40, v45
  v_fma_f32 v111, -v41, v45, v111
  v_fma_f32 v127, -v41, v44, v127

  s_lshl_b32 s5, s45, 11
  s_add_u32 s5, s5, 57600
  v_lshlrev_b32 v7, 6, v1
  v_lshl_add_u32 v7, v2, 5, v7
  v_add_u32 v7, s5, v7
  v_bfe_u32 v4, v0, 2, 2
  v_lshl_add_u32 v4, v2, 3, v4
  v_lshlrev_b32 v4, 6, v4
  v_and_b32 v5, 1, v0
  v_lshl_add_u32 v4, v5, 5, v4
  v_bfe_u32 v5, v0, 4, 1
  v_lshl_add_u32 v4, v5, 4, v4
  v_bfe_u32 v5, v0, 1, 1
  v_lshl_add_u32 v4, v5, 3, v4
  v_add_u32 v4, s5, v4
  v_lshlrev_b32 v14, 4, v0

  v_cvt_pk_bf16_f32 v48, v96, v97
  v_cvt_pk_bf16_f32 v49, v98, v99
  v_cvt_pk_bf16_f32 v50, v100, v101
  v_cvt_pk_bf16_f32 v51, v102, v103
  v_cvt_pk_bf16_f32 v52, v104, v105
  v_cvt_pk_bf16_f32 v53, v106, v107
  v_cvt_pk_bf16_f32 v54, v108, v109
  v_cvt_pk_bf16_f32 v55, v110, v111
  ds_write_b128 v7, v[48:51]
  ds_write_b128 v7, v[52:55] offset:16
  s_waitcnt lgkmcnt(0)
  ds_read_b64_tr_b16 v[56:57], v4 offset:0
  ds_read_b64_tr_b16 v[58:59], v4 offset:256
  ds_read_b64_tr_b16 v[60:61], v4 offset:1024
  ds_read_b64_tr_b16 v[62:63], v4 offset:1280
  s_waitcnt lgkmcnt(0)
  s_lshl_b32 s6, s47, 11
  s_add_u32 s6, s6, s61
  s_add_u32 s6, s6, 114688
  buffer_store_dwordx4 v[56:59], v14, s[20:23], s6 offen sc1

  s_lshl_b32 s6, s47, 11
  s_add_u32 s6, s6, s61
  s_add_u32 s6, s6, 115712
  buffer_store_dwordx4 v[60:63], v14, s[20:23], s6 offen sc1

  s_nop 1
  v_cvt_pk_bf16_f32 v48, v112, v113
  v_cvt_pk_bf16_f32 v49, v114, v115
  v_cvt_pk_bf16_f32 v50, v116, v117
  v_cvt_pk_bf16_f32 v51, v118, v119
  v_cvt_pk_bf16_f32 v52, v120, v121
  v_cvt_pk_bf16_f32 v53, v122, v123
  v_cvt_pk_bf16_f32 v54, v124, v125
  v_cvt_pk_bf16_f32 v55, v126, v127
  ds_write_b128 v7, v[48:51]
  ds_write_b128 v7, v[52:55] offset:16
  s_waitcnt lgkmcnt(0)
  ds_read_b64_tr_b16 v[56:57], v4 offset:0
  ds_read_b64_tr_b16 v[58:59], v4 offset:256
  ds_read_b64_tr_b16 v[60:61], v4 offset:1024
  ds_read_b64_tr_b16 v[62:63], v4 offset:1280
  s_waitcnt lgkmcnt(0)
  s_lshl_b32 s6, s47, 11
  s_add_u32 s6, s6, s61
  s_add_u32 s6, s6, 147456
  buffer_store_dwordx4 v[56:59], v14, s[20:23], s6 offen sc1

  s_lshl_b32 s6, s47, 11
  s_add_u32 s6, s6, s61
  s_add_u32 s6, s6, 148480
  buffer_store_dwordx4 v[60:63], v14, s[20:23], s6 offen sc1

  s_nop 1
  ds_read_b64_tr_b16 v[16:17], v47 offset:3584
  ds_read_b64_tr_b16 v[18:19], v47 offset:4480
  s_waitcnt lgkmcnt(4)
  v_mfma_f32_32x32x16_bf16 v[64:79], v[20:23], a[80:83], v[64:79]
  ds_read_b64_tr_b16 v[20:21], v47 offset:3616
  ds_read_b64_tr_b16 v[22:23], v47 offset:4512
  s_waitcnt lgkmcnt(4)
  v_mfma_f32_32x32x16_bf16 v[80:95], v[24:27], a[80:83], v[80:95]
  ds_read_b64_tr_b16 v[24:25], v47 offset:7168
  ds_read_b64_tr_b16 v[26:27], v47 offset:8064
  s_waitcnt lgkmcnt(4)
  v_mfma_f32_32x32x16_bf16 v[64:79], v[16:19], a[84:87], v[64:79]
  ds_read_b64_tr_b16 v[16:17], v47 offset:7200
  ds_read_b64_tr_b16 v[18:19], v47 offset:8096
  s_waitcnt lgkmcnt(4)
  v_mfma_f32_32x32x16_bf16 v[80:95], v[20:23], a[84:87], v[80:95]
  ds_read_b64_tr_b16 v[20:21], v47 offset:10752
  ds_read_b64_tr_b16 v[22:23], v47 offset:11648
  s_waitcnt lgkmcnt(4)
  v_mfma_f32_32x32x16_bf16 v[64:79], v[24:27], a[88:91], v[64:79]
  ds_read_b64_tr_b16 v[24:25], v47 offset:10784
  ds_read_b64_tr_b16 v[26:27], v47 offset:11680
  s_waitcnt lgkmcnt(4)
  v_mfma_f32_32x32x16_bf16 v[80:95], v[16:19], a[88:91], v[80:95]
  v_add_u32 v47, 86400, v46
  ds_read_b64_tr_b16 v[16:17], v47 offset:0
  ds_read_b64_tr_b16 v[18:19], v47 offset:896
  s_waitcnt lgkmcnt(4)
  v_mfma_f32_32x32x16_bf16 v[64:79], v[20:23], a[92:95], v[64:79]
  ds_read_b64_tr_b16 v[20:21], v47 offset:32
  ds_read_b64_tr_b16 v[22:23], v47 offset:928
  s_waitcnt lgkmcnt(4)
  v_mfma_f32_32x32x16_bf16 v[80:95], v[24:27], a[92:95], v[80:95]
  ds_read_b64_tr_b16 v[24:25], v47 offset:3584
  ds_read_b64_tr_b16 v[26:27], v47 offset:4480
  s_waitcnt lgkmcnt(4)
  v_mfma_f32_32x32x16_bf16 v[64:79], v[16:19], a[96:99], v[64:79]
  ds_read_b64_tr_b16 v[16:17], v47 offset:3616
  ds_read_b64_tr_b16 v[18:19], v47 offset:4512
  s_waitcnt lgkmcnt(4)
  v_mfma_f32_32x32x16_bf16 v[80:95], v[20:23], a[96:99], v[80:95]
  ds_read_b64_tr_b16 v[20:21], v47 offset:7168
  ds_read_b64_tr_b16 v[22:23], v47 offset:8064
  s_waitcnt lgkmcnt(4)
  v_mfma_f32_32x32x16_bf16 v[64:79], v[24:27], a[100:103], v[64:79]
  ds_read_b64_tr_b16 v[24:25], v47 offset:7200
  ds_read_b64_tr_b16 v[26:27], v47 offset:8096
  s_waitcnt lgkmcnt(4)
  v_mfma_f32_32x32x16_bf16 v[80:95], v[16:19], a[100:103], v[80:95]
  ds_read_b64_tr_b16 v[16:17], v47 offset:10752
  ds_read_b64_tr_b16 v[18:19], v47 offset:11648
  s_waitcnt lgkmcnt(4)
  v_mfma_f32_32x32x16_bf16 v[64:79], v[20:23], a[104:107], v[64:79]
  ds_read_b64_tr_b16 v[20:21], v47 offset:10784
  ds_read_b64_tr_b16 v[22:23], v47 offset:11680
  s_waitcnt lgkmcnt(4)
  v_mfma_f32_32x32x16_bf16 v[80:95], v[24:27], a[104:107], v[80:95]
  v_add_u32 v47, 0, v46
  ds_read_b64_tr_b16 v[24:25], v47 offset:0
  ds_read_b64_tr_b16 v[26:27], v47 offset:896
  s_waitcnt lgkmcnt(4)
  v_mfma_f32_32x32x16_bf16 v[64:79], v[16:19], a[108:111], v[64:79]
  ds_read_b64_tr_b16 v[16:17], v47 offset:32
  ds_read_b64_tr_b16 v[18:19], v47 offset:928
  s_waitcnt lgkmcnt(4)
  v_mfma_f32_32x32x16_bf16 v[80:95], v[20:23], a[108:111], v[80:95]
  ds_read_b64_tr_b16 v[20:21], v47 offset:3584
  ds_read_b64_tr_b16 v[22:23], v47 offset:4480
  s_waitcnt lgkmcnt(4)
  v_mfma_f32_32x32x16_bf16 v[64:79], v[24:27], a[112:115], v[64:79]
  ds_read_b64_tr_b16 v[24:25], v47 offset:3616
  ds_read_b64_tr_b16 v[26:27], v47 offset:4512
  s_waitcnt lgkmcnt(4)
  v_mfma_f32_32x32x16_bf16 v[80:95], v[16:19], a[112:115], v[80:95]
  ds_read_b64_tr_b16 v[16:17], v47 offset:7168
  ds_read_b64_tr_b16 v[18:19], v47 offset:8064
  s_waitcnt lgkmcnt(4)
  v_mfma_f32_32x32x16_bf16 v[64:79], v[20:23], a[116:119], v[64:79]
  ds_read_b64_tr_b16 v[20:21], v47 offset:7200
  ds_read_b64_tr_b16 v[22:23], v47 offset:8096
  s_waitcnt lgkmcnt(4)
  v_mfma_f32_32x32x16_bf16 v[80:95], v[24:27], a[116:119], v[80:95]
  ds_read_b64_tr_b16 v[24:25], v47 offset:10752
  ds_read_b64_tr_b16 v[26:27], v47 offset:11648
  s_waitcnt lgkmcnt(4)
  v_mfma_f32_32x32x16_bf16 v[64:79], v[16:19], a[120:123], v[64:79]
  ds_read_b64_tr_b16 v[16:17], v47 offset:10784
  ds_read_b64_tr_b16 v[18:19], v47 offset:11680
  s_waitcnt lgkmcnt(4)
  v_mfma_f32_32x32x16_bf16 v[80:95], v[20:23], a[120:123], v[80:95]
  s_waitcnt lgkmcnt(2)
  v_mfma_f32_32x32x16_bf16 v[64:79], v[24:27], a[124:127], v[64:79]
  s_waitcnt lgkmcnt(0)
  v_mfma_f32_32x32x16_bf16 v[80:95], v[16:19], a[124:127], v[80:95]
  v_lshlrev_b32 v7, 2, v1
  v_add_u32 v7, 159872, v7
  ds_read_b32 v12, v7
  ds_read_b32 v13, v7 offset:128

  v_xor_b32 v16, 0x80000000, v32
  v_lshrrev_b32 v17, 16, v16
  v_and_b32 v16, 0xffff0000, v16
  v_or_b32 v16, v16, v17
  v_cmp_gt_u32 vcc, 32, v0
  s_nop 1
  v_cndmask_b32 v16, 0, v16, vcc
  v_cndmask_b32 v17, 0, v17, vcc
  v_mov_b32 v18, 0
  v_mov_b32 v19, 0

  s_waitcnt lgkmcnt(0)
  v_cvt_pk_bf16_f32 v4, v12, v12
  v_and_b32 v5, 0xffff0000, v4
  v_sub_f32 v12, v12, v5
  v_cvt_pk_bf16_f32 v6, v12, v12
  v_and_b32 v6, 0xffff0000, v6
  v_sub_f32 v12, v12, v6
  v_lshrrev_b32 v5, 16, v5
  v_or_b32 v20, v5, v6
  v_cvt_pk_bf16_f32 v21, v12, v12
  v_and_b32 v21, 0xffff, v21
  v_mov_b32 v22, 0
  v_mov_b32 v23, 0
  s_nop 1

  v_mfma_f32_32x32x16_bf16 v[64:79], v[20:23], v[16:19], v[64:79]
  v_cvt_pk_bf16_f32 v4, v13, v13
  v_and_b32 v5, 0xffff0000, v4
  v_sub_f32 v13, v13, v5
  v_cvt_pk_bf16_f32 v6, v13, v13
  v_and_b32 v6, 0xffff0000, v6
  v_sub_f32 v13, v13, v6
  v_lshrrev_b32 v5, 16, v5
  v_or_b32 v20, v5, v6
  v_cvt_pk_bf16_f32 v21, v13, v13
  v_and_b32 v21, 0xffff, v21
  v_mov_b32 v22, 0
  v_mov_b32 v23, 0
  s_nop 1

  v_mfma_f32_32x32x16_bf16 v[80:95], v[20:23], v[16:19], v[80:95]
  v_mul_f32 v12, 0xbfb8aa3b, v33
  v_mul_f32 v13, v33, v33
  v_rcp_f32 v13, v13
  v_lshlrev_b32 v14, 4, v0
  s_mul_i32 s6, s47, 7168
  s_add_u32 s5, s61, s6

  s_nop 11
  v_mul_f32 v4, v64, v12
  v_mul_f32 v6, v65, v12
  v_exp_f32 v4, v4
  v_exp_f32 v6, v6
  v_mul_f32 v5, v64, v72
  v_mul_f32 v7, v65, v73
  v_fma_f32 v4, v4, v13, v13
  v_fma_f32 v6, v6, v13, v13
  v_rcp_f32 v4, v4
  v_rcp_f32 v6, v6
  s_nop 0
  v_mul_f32 v5, v5, v4
  v_mul_f32 v7, v7, v6
  v_cvt_pk_bf16_f32 v24, v5, v7

  v_mul_f32 v4, v66, v12
  v_mul_f32 v6, v67, v12
  v_exp_f32 v4, v4
  v_exp_f32 v6, v6
  v_mul_f32 v5, v66, v74
  v_mul_f32 v7, v67, v75
  v_fma_f32 v4, v4, v13, v13
  v_fma_f32 v6, v6, v13, v13
  v_rcp_f32 v4, v4
  v_rcp_f32 v6, v6
  s_nop 0
  v_mul_f32 v5, v5, v4
  v_mul_f32 v7, v7, v6
  v_cvt_pk_bf16_f32 v25, v5, v7

  v_mul_f32 v4, v68, v12
  v_mul_f32 v6, v69, v12
  v_exp_f32 v4, v4
  v_exp_f32 v6, v6
  v_mul_f32 v5, v68, v76
  v_mul_f32 v7, v69, v77
  v_fma_f32 v4, v4, v13, v13
  v_fma_f32 v6, v6, v13, v13
  v_rcp_f32 v4, v4
  v_rcp_f32 v6, v6
  s_nop 0
  v_mul_f32 v5, v5, v4
  v_mul_f32 v7, v7, v6
  v_cvt_pk_bf16_f32 v26, v5, v7

  v_mul_f32 v4, v70, v12
  v_mul_f32 v6, v71, v12
  v_exp_f32 v4, v4
  v_exp_f32 v6, v6
  v_mul_f32 v5, v70, v78
  v_mul_f32 v7, v71, v79
  v_fma_f32 v4, v4, v13, v13
  v_fma_f32 v6, v6, v13, v13
  v_rcp_f32 v4, v4
  v_rcp_f32 v6, v6
  s_nop 0
  v_mul_f32 v5, v5, v4
  v_mul_f32 v7, v7, v6
  v_cvt_pk_bf16_f32 v27, v5, v7

  s_add_u32 s6, s5, 0
  buffer_store_dwordx4 v[24:27], v14, s[20:23], s6 offen sc1
  v_mul_f32 v4, v80, v12
  v_mul_f32 v6, v81, v12
  v_exp_f32 v4, v4
  v_exp_f32 v6, v6
  v_mul_f32 v5, v80, v88
  v_mul_f32 v7, v81, v89
  v_fma_f32 v4, v4, v13, v13
  v_fma_f32 v6, v6, v13, v13
  v_rcp_f32 v4, v4
  v_rcp_f32 v6, v6
  s_nop 0
  v_mul_f32 v5, v5, v4
  v_mul_f32 v7, v7, v6
  v_cvt_pk_bf16_f32 v28, v5, v7

  v_mul_f32 v4, v82, v12
  v_mul_f32 v6, v83, v12
  v_exp_f32 v4, v4
  v_exp_f32 v6, v6
  v_mul_f32 v5, v82, v90
  v_mul_f32 v7, v83, v91
  v_fma_f32 v4, v4, v13, v13
  v_fma_f32 v6, v6, v13, v13
  v_rcp_f32 v4, v4
  v_rcp_f32 v6, v6
  s_nop 0
  v_mul_f32 v5, v5, v4
  v_mul_f32 v7, v7, v6
  v_cvt_pk_bf16_f32 v29, v5, v7

  v_mul_f32 v4, v84, v12
  v_mul_f32 v6, v85, v12
  v_exp_f32 v4, v4
  v_exp_f32 v6, v6
  v_mul_f32 v5, v84, v92
  v_mul_f32 v7, v85, v93
  v_fma_f32 v4, v4, v13, v13
  v_fma_f32 v6, v6, v13, v13
  v_rcp_f32 v4, v4
  v_rcp_f32 v6, v6
  s_nop 0
  v_mul_f32 v5, v5, v4
  v_mul_f32 v7, v7, v6
  v_cvt_pk_bf16_f32 v30, v5, v7

  v_mul_f32 v4, v86, v12
  v_mul_f32 v6, v87, v12
  v_exp_f32 v4, v4
  v_exp_f32 v6, v6
  v_mul_f32 v5, v86, v94
  v_mul_f32 v7, v87, v95
  v_fma_f32 v4, v4, v13, v13
  v_fma_f32 v6, v6, v13, v13
  v_rcp_f32 v4, v4
  v_rcp_f32 v6, v6
  s_nop 0
  v_mul_f32 v5, v5, v4
  v_mul_f32 v7, v7, v6
  v_cvt_pk_bf16_f32 v31, v5, v7

  s_add_u32 s6, s5, 1024
  buffer_store_dwordx4 v[28:31], v14, s[20:23], s6 offen sc1
  s_branch LB_dphase
LB_c1:
  s_add_u32 m0, s56, 0
  s_nop 0
  buffer_load_dwordx4 v4, s[8:11], s48 offen lds
  s_add_u32 m0, s56, 1024
  s_nop 0
  buffer_load_dwordx4 v5, s[8:11], s48 offen lds
  s_add_u32 m0, s56, 2048
  s_add_u32 s60, s48, 16384
  buffer_load_dwordx4 v4, s[8:11], s60 offen lds
  s_add_u32 m0, s56, 3072
  s_add_u32 s60, s48, 16384
  buffer_load_dwordx4 v5, s[8:11], s60 offen lds
  s_add_u32 m0, s57, 0
  s_nop 0
  buffer_load_dwordx4 v6, s[12:15], s48 offen lds
  s_add_u32 m0, s57, 1024
  s_nop 0
  buffer_load_dwordx4 v7, s[12:15], s48 offen lds
  s_lshl_b32 s5, s46, 5
  v_add_u32 v20, s5, v1
  v_lshlrev_b32 v20, 10, v20
  v_lshl_add_u32 v20, v2, 4, v20
  s_lshl_b32 s5, s47, 6
  s_and_b32 s6, s45, 1
  s_lshl_b32 s6, s6, 5
  s_add_u32 s5, s5, s6
  v_add_u32 v20, s5, v20
  s_cmp_lt_u32 s45, 2
  s_cselect_b32 s6, s74, s76
  s_cselect_b32 s7, s75, s77

  global_load_dwordx4 v[24:27], v20, s[6:7]
  s_mul_i32 s5, s47, 112
  s_lshl_b32 s6, s44, 4
  s_add_u32 s5, s5, s6
  v_lshrrev_b32 v28, 2, v0
  v_add_u32 v28, s5, v28
  v_lshlrev_b32 v28, 10, v28
  v_and_b32 v29, 3, v0
  v_lshl_add_u32 v28, v29, 4, v28
  s_lshl_b32 s5, s46, 6
  v_add_u32 v28, s5, v28
  s_lshl_b32 s5, s44, 10
  s_add_u32 s5, s5, 151680
  s_mov_b32 m0, s5

  s_cmp_ge_u32 s44, 7
  s_cbranch_scc1 LB_skipw2_1
  buffer_load_dwordx4 v28, s[24:27], 0 offen lds
LB_skipw2_1:
  s_lshl_b32 s5, s45, 5
  v_add_u32 v36, s5, v3
  v_bfe_u32 v37, v36, 1, 3
  v_xor_b32 v37, v37, v2
  v_lshlrev_b32 v37, 4, v37
  v_lshl_add_u32 v8, v36, 7, v37
  v_xor_b32 v9, 32, v8
  v_xor_b32 v10, 64, v8
  v_xor_b32 v11, 96, v8

  s_and_b32 s5, s45, 1
  s_mul_i32 s5, s5, 4
  s_add_u32 s5, s5, 0
  s_lshl_b32 s59, s5, 10
  s_lshl_b32 s5, s5, 6
  s_mul_i32 s6, s47, 224
  s_mov_b32 s7, 0x12492493

  v_add_u32 v36, s5, v0
  v_add_u32 v36, 0, v36
  v_mul_hi_u32 v37, v36, s7
  v_mul_u32_u24 v38, 14, v37
  v_sub_u32 v38, v36, v38
  v_mul_u32_u24 v37, 3584, v37
  v_lshl_add_u32 v37, v38, 4, v37
  v_add_u32 v12, s6, v37

  v_add_u32 v36, s5, v0
  v_add_u32 v36, 64, v36
  v_mul_hi_u32 v37, v36, s7
  v_mul_u32_u24 v38, 14, v37
  v_sub_u32 v38, v36, v38
  v_mul_u32_u24 v37, 3584, v37
  v_lshl_add_u32 v37, v38, 4, v37
  v_add_u32 v13, s6, v37

  v_add_u32 v36, s5, v0
  v_add_u32 v36, 128, v36
  v_mul_hi_u32 v37, v36, s7
  v_mul_u32_u24 v38, 14, v37
  v_sub_u32 v38, v36, v38
  v_mul_u32_u24 v37, 3584, v37
  v_lshl_add_u32 v37, v38, 4, v37
  v_add_u32 v14, s6, v37

  v_add_u32 v36, s5, v0
  v_add_u32 v36, 192, v36
  v_mul_hi_u32 v37, v36, s7
  v_mul_u32_u24 v38, 14, v37
  v_sub_u32 v38, v36, v38
  v_mul_u32_u24 v37, 3584, v37
  v_lshl_add_u32 v37, v38, 4, v37
  v_add_u32 v15, s6, v37

  s_lshr_b32 s5, s45, 1
  s_mul_i32 s5, s5, 14464
  s_add_u32 s59, s59, s5

  s_mul_i32 s72, s48, 1792
  s_mul_i32 s73, s49, 1792
  s_mul_i32 s74, s50, 1792
  s_mul_i32 s75, s51, 1792
  s_mul_i32 s76, s52, 1792
  s_mul_i32 s77, s53, 1792
  s_mul_i32 s78, s54, 1792
  s_mul_i32 s79, s55, 1792
  v_bfe_u32 v36, v0, 2, 2
  v_lshl_add_u32 v36, v2, 3, v36
  v_mul_u32_u24 v41, 224, v36
  v_and_b32 v36, 3, v0
  v_lshl_add_u32 v41, v36, 3, v41
  v_bfe_u32 v36, v0, 4, 1
  v_mul_u32_u24 v36, 14464, v36
  v_add_u32 v41, v41, v36

  s_lshl_b32 s5, s45, 5
  v_and_b32 v36, 15, v0
  v_add_u32 v36, s5, v36
  v_bfe_u32 v37, v36, 1, 3
  v_lshrrev_b32 v38, 4, v0
  v_xor_b32 v37, v37, v38
  v_lshlrev_b32 v37, 4, v37
  v_lshl_add_u32 v16, v36, 7, v37
  v_xor_b32 v17, 64, v16

  v_mov_b32 v64, 0
  v_mov_b32 v65, 0
  v_mov_b32 v66, 0
  v_mov_b32 v67, 0
  v_mov_b32 v68, 0
  v_mov_b32 v69, 0
  v_mov_b32 v70, 0
  v_mov_b32 v71, 0
  v_mov_b32 v72, 0
  v_mov_b32 v73, 0
  v_mov_b32 v74, 0
  v_mov_b32 v75, 0
  v_mov_b32 v76, 0
  v_mov_b32 v77, 0
  v_mov_b32 v78, 0
  v_mov_b32 v79, 0
  v_mov_b32 v20, 0x3f803f80
  v_mov_b32 v21, 0x3f803f80
  v_mov_b32 v22, 0x3f803f80
  v_mov_b32 v23, 0x3f803f80
  s_add_u32 m0, s56, 24576
  s_nop 0
  buffer_load_dwordx4 v4, s[8:11], s49 offen lds
  s_add_u32 m0, s56, 25600
  s_nop 0
  buffer_load_dwordx4 v5, s[8:11], s49 offen lds
  s_add_u32 m0, s56, 26624
  s_add_u32 s60, s49, 16384
  buffer_load_dwordx4 v4, s[8:11], s60 offen lds
  s_add_u32 m0, s56, 27648
  s_add_u32 s60, s49, 16384
  buffer_load_dwordx4 v5, s[8:11], s60 offen lds
  s_add_u32 m0, s57, 24576
  s_nop 0
  buffer_load_dwordx4 v6, s[12:15], s49 offen lds
  s_add_u32 m0, s57, 25600
  s_nop 0
  buffer_load_dwordx4 v7, s[12:15], s49 offen lds
  s_waitcnt vmcnt(7)
  s_barrier
  ds_read_b128 a[0:3], v8 offset:0
  ds_read_b128 a[4:7], v9 offset:0
  ds_read_b128 a[8:11], v10 offset:0
  ds_read_b128 a[12:15], v11 offset:0
  ds_read_b128 v[48:51], v16 offset:0
  ds_read_b128 v[52:55], v17 offset:0
  ds_read_b128 v[56:59], v16 offset:2048
  ds_read_b128 v[60:63], v17 offset:2048
  s_add_u32 m0, s56, 49152
  s_nop 0
  buffer_load_dwordx4 v4, s[8:11], s50 offen lds
  s_add_u32 m0, s56, 50176
  s_nop 0
  buffer_load_dwordx4 v5, s[8:11], s50 offen lds
  s_add_u32 m0, s56, 51200
  s_add_u32 s60, s50, 16384
  buffer_load_dwordx4 v4, s[8:11], s60 offen lds
  s_add_u32 m0, s56, 52224
  s_add_u32 s60, s50, 16384
  buffer_load_dwordx4 v5, s[8:11], s60 offen lds
  s_add_u32 m0, s57, 49152
  s_nop 0
  buffer_load_dwordx4 v6, s[12:15], s50 offen lds
  s_add_u32 m0, s57, 50176
  s_nop 0
  buffer_load_dwordx4 v7, s[12:15], s50 offen lds
  s_add_u32 m0, s56, 73728
  s_nop 0
  buffer_load_dwordx4 v4, s[8:11], s51 offen lds
  s_add_u32 m0, s56, 74752
  s_nop 0
  buffer_load_dwordx4 v5, s[8:11], s51 offen lds
  s_add_u32 m0, s56, 75776
  s_add_u32 s60, s51, 16384
  buffer_load_dwordx4 v4, s[8:11], s60 offen lds
  s_add_u32 m0, s56, 76800
  s_add_u32 s60, s51, 16384
  buffer_load_dwordx4 v5, s[8:11], s60 offen lds
  s_add_u32 m0, s57, 73728
  s_nop 0
  buffer_load_dwordx4 v6, s[12:15], s51 offen lds
  s_add_u32 m0, s57, 74752
  s_nop 0
  buffer_load_dwordx4 v7, s[12:15], s51 offen lds
  s_waitcnt lgkmcnt(3)
  v_mfma_f32_16x16x32_bf16 v[64:67], v[20:23], v[48:51], v[64:67]
  v_mfma_f32_16x16x32_bf16 v[72:75], v[48:51], v[48:51], v[72:75]
  s_waitcnt lgkmcnt(2)
  v_mfma_f32_16x16x32_bf16 v[64:67], v[20:23], v[52:55], v[64:67]
  v_mfma_f32_16x16x32_bf16 v[72:75], v[52:55], v[52:55], v[72:75]
  s_waitcnt lgkmcnt(1)
  v_mfma_f32_16x16x32_bf16 v[68:71], v[20:23], v[56:59], v[68:71]
  v_mfma_f32_16x16x32_bf16 v[76:79], v[56:59], v[56:59], v[76:79]
  s_waitcnt lgkmcnt(0)
  v_mfma_f32_16x16x32_bf16 v[68:71], v[20:23], v[60:63], v[68:71]
  v_mfma_f32_16x16x32_bf16 v[76:79], v[60:63], v[60:63], v[76:79]
  s_waitcnt vmcnt(18)
  s_mul_i32 s5, s46, 180224
  s_lshr_b32 s6, s45, 1
  s_lshl_b32 s6, s6, 5
  s_add_u32 s6, s6, 112
  s_lshl_b32 s7, s47, 1
  s_add_u32 s6, s6, s7
  s_and_b32 s7, s45, 1
  s_add_u32 s6, s6, s7
  s_lshl_b32 s6, s6, 10
  s_add_u32 s5, s5, s6
  s_add_u32 s5, s5, 11534336
  v_lshlrev_b32 v28, 4, v0
  buffer_store_dwordx4 v[24:27], v28, s[20:23], s5 offen sc1

  s_waitcnt lgkmcnt(0)
  s_waitcnt vmcnt(12)
  s_barrier
  ds_read_b128 a[16:19], v8 offset:24576
  ds_read_b128 a[20:23], v9 offset:24576
  ds_read_b128 a[24:27], v10 offset:24576
  ds_read_b128 a[28:31], v11 offset:24576
  ds_read_b128 v[48:51], v16 offset:24576
  ds_read_b128 v[52:55], v17 offset:24576
  ds_read_b128 v[56:59], v16 offset:26624
  ds_read_b128 v[60:63], v17 offset:26624
  s_add_u32 m0, s56, 98304
  s_nop 0
  buffer_load_dwordx4 v4, s[8:11], s52 offen lds
  s_add_u32 m0, s56, 99328
  s_nop 0
  buffer_load_dwordx4 v5, s[8:11], s52 offen lds
  s_add_u32 m0, s56, 100352
  s_add_u32 s60, s52, 16384
  buffer_load_dwordx4 v4, s[8:11], s60 offen lds
  s_add_u32 m0, s56, 101376
  s_add_u32 s60, s52, 16384
  buffer_load_dwordx4 v5, s[8:11], s60 offen lds
  s_add_u32 m0, s57, 98304
  s_nop 0
  buffer_load_dwordx4 v6, s[12:15], s52 offen lds
  s_add_u32 m0, s57, 99328
  s_nop 0
  buffer_load_dwordx4 v7, s[12:15], s52 offen lds
  s_add_u32 m0, s59, 122880
  s_nop 0
  buffer_load_dwordx4 v12, s[16:19], s72 offen lds
  s_add_u32 m0, s59, 123904
  s_nop 0
  buffer_load_dwordx4 v13, s[16:19], s72 offen lds
  s_add_u32 m0, s59, 124928
  s_nop 0
  buffer_load_dwordx4 v14, s[16:19], s72 offen lds
  s_add_u32 m0, s59, 125952
  s_nop 0
  buffer_load_dwordx4 v15, s[16:19], s72 offen lds
  s_waitcnt lgkmcnt(3)
  v_mfma_f32_16x16x32_bf16 v[64:67], v[20:23], v[48:51], v[64:67]
  v_mfma_f32_16x16x32_bf16 v[72:75], v[48:51], v[48:51], v[72:75]
  s_waitcnt lgkmcnt(2)
  v_mfma_f32_16x16x32_bf16 v[64:67], v[20:23], v[52:55], v[64:67]
  v_mfma_f32_16x16x32_bf16 v[72:75], v[52:55], v[52:55], v[72:75]
  s_waitcnt lgkmcnt(1)
  v_mfma_f32_16x16x32_bf16 v[68:71], v[20:23], v[56:59], v[68:71]
  v_mfma_f32_16x16x32_bf16 v[76:79], v[56:59], v[56:59], v[76:79]
  s_waitcnt lgkmcnt(0)
  v_mfma_f32_16x16x32_bf16 v[68:71], v[20:23], v[60:63], v[68:71]
  v_mfma_f32_16x16x32_bf16 v[76:79], v[60:63], v[60:63], v[76:79]
  s_cmp_ge_u32 s44, 7
  s_cbranch_scc1 LB_skipw2b_1
  v_bfe_u32 v28, v0, 2, 2
  v_lshl_add_u32 v28, v2, 2, v28
  v_lshlrev_b32 v28, 6, v28
  v_bfe_u32 v29, v0, 4, 1
  v_lshl_add_u32 v28, v29, 5, v28
  v_and_b32 v29, 3, v0
  v_lshl_add_u32 v28, v29, 3, v28
  s_lshl_b32 s5, s44, 10
  s_add_u32 s5, s5, 151680
  v_add_u32 v28, s5, v28
  ds_read_b64_tr_b16 v[32:33], v28
  ds_read_b64_tr_b16 v[34:35], v28 offset:512
  s_mul_i32 s5, s46, 180224
  s_mul_i32 s6, s47, 7
  s_add_u32 s6, s6, s44
  s_lshl_b32 s6, s6, 10
  s_add_u32 s5, s5, s6
  s_add_u32 s5, s5, 11534336
  v_lshlrev_b32 v29, 4, v0
  s_waitcnt lgkmcnt(0)

  buffer_store_dwordx4 v[32:35], v29, s[20:23], s5 offen sc1
LB_skipw2b_1:
  s_waitcnt lgkmcnt(0)
  s_waitcnt vmcnt(16)
  s_barrier
  ds_read_b128 a[32:35], v8 offset:49152
  ds_read_b128 a[36:39], v9 offset:49152
  ds_read_b128 a[40:43], v10 offset:49152
  ds_read_b128 a[44:47], v11 offset:49152
  ds_read_b128 v[48:51], v16 offset:49152
  ds_read_b128 v[52:55], v17 offset:49152
  ds_read_b128 v[56:59], v16 offset:51200
  ds_read_b128 v[60:63], v17 offset:51200
  s_add_u32 m0, s56, 0
  s_nop 0
  buffer_load_dwordx4 v4, s[8:11], s53 offen lds
  s_add_u32 m0, s56, 1024
  s_nop 0
  buffer_load_dwordx4 v5, s[8:11], s53 offen lds
  s_add_u32 m0, s56, 2048
  s_add_u32 s60, s53, 16384
  buffer_load_dwordx4 v4, s[8:11], s60 offen lds
  s_add_u32 m0, s56, 3072
  s_add_u32 s60, s53, 16384
  buffer_load_dwordx4 v5, s[8:11], s60 offen lds
  s_add_u32 m0, s57, 0
  s_nop 0
  buffer_load_dwordx4 v6, s[12:15], s53 offen lds
  s_add_u32 m0, s57, 1024
  s_nop 0
  buffer_load_dwordx4 v7, s[12:15], s53 offen lds
  s_waitcnt lgkmcnt(3)
  v_mfma_f32_16x16x32_bf16 v[64:67], v[20:23], v[48:51], v[64:67]
  v_mfma_f32_16x16x32_bf16 v[72:75], v[48:51], v[48:51], v[72:75]
  s_waitcnt lgkmcnt(2)
  v_mfma_f32_16x16x32_bf16 v[64:67], v[20:23], v[52:55], v[64:67]
  v_mfma_f32_16x16x32_bf16 v[72:75], v[52:55], v[52:55], v[72:75]
  s_waitcnt lgkmcnt(1)
  v_mfma_f32_16x16x32_bf16 v[68:71], v[20:23], v[56:59], v[68:71]
  v_mfma_f32_16x16x32_bf16 v[76:79], v[56:59], v[56:59], v[76:79]
  s_waitcnt lgkmcnt(0)
  v_mfma_f32_16x16x32_bf16 v[68:71], v[20:23], v[60:63], v[68:71]
  v_mfma_f32_16x16x32_bf16 v[76:79], v[60:63], v[60:63], v[76:79]
  s_waitcnt lgkmcnt(0)
  s_waitcnt vmcnt(16)
  s_barrier
  v_add_u32 v8, 73728, v8
  v_add_u32 v9, 73728, v9
  v_add_u32 v10, 73728, v10
  v_add_u32 v11, 73728, v11
  v_add_u32 v16, 73728, v16
  v_add_u32 v17, 73728, v17
  ds_read_b128 a[48:51], v8 offset:0
  ds_read_b128 a[52:55], v9 offset:0
  ds_read_b128 a[56:59], v10 offset:0
  ds_read_b128 a[60:63], v11 offset:0
  ds_read_b128 v[48:51], v16 offset:0
  ds_read_b128 v[52:55], v17 offset:0
  ds_read_b128 v[56:59], v16 offset:2048
  ds_read_b128 v[60:63], v17 offset:2048
  s_add_u32 m0, s56, 24576
  s_nop 0
  buffer_load_dwordx4 v4, s[8:11], s54 offen lds
  s_add_u32 m0, s56, 25600
  s_nop 0
  buffer_load_dwordx4 v5, s[8:11], s54 offen lds
  s_add_u32 m0, s56, 26624
  s_add_u32 s60, s54, 16384
  buffer_load_dwordx4 v4, s[8:11], s60 offen lds
  s_add_u32 m0, s56, 27648
  s_add_u32 s60, s54, 16384
  buffer_load_dwordx4 v5, s[8:11], s60 offen lds
  s_add_u32 m0, s57, 24576
  s_nop 0
  buffer_load_dwordx4 v6, s[12:15], s54 offen lds
  s_add_u32 m0, s57, 25600
  s_nop 0
  buffer_load_dwordx4 v7, s[12:15], s54 offen lds
  s_waitcnt lgkmcnt(3)
  v_mfma_f32_16x16x32_bf16 v[64:67], v[20:23], v[48:51], v[64:67]
  v_mfma_f32_16x16x32_bf16 v[72:75], v[48:51], v[48:51], v[72:75]
  s_waitcnt lgkmcnt(2)
  v_mfma_f32_16x16x32_bf16 v[64:67], v[20:23], v[52:55], v[64:67]
  v_mfma_f32_16x16x32_bf16 v[72:75], v[52:55], v[52:55], v[72:75]
  s_waitcnt lgkmcnt(1)
  v_mfma_f32_16x16x32_bf16 v[68:71], v[20:23], v[56:59], v[68:71]
  v_mfma_f32_16x16x32_bf16 v[76:79], v[56:59], v[56:59], v[76:79]
  s_waitcnt lgkmcnt(0)
  v_mfma_f32_16x16x32_bf16 v[68:71], v[20:23], v[60:63], v[68:71]
  v_mfma_f32_16x16x32_bf16 v[76:79], v[60:63], v[60:63], v[76:79]
  s_waitcnt lgkmcnt(0)
  s_waitcnt vmcnt(16)
  s_barrier
  ds_read_b128 a[64:67], v8 offset:24576
  ds_read_b128 a[68:71], v9 offset:24576
  ds_read_b128 a[72:75], v10 offset:24576
  ds_read_b128 a[76:79], v11 offset:24576
  ds_read_b128 v[48:51], v16 offset:24576
  ds_read_b128 v[52:55], v17 offset:24576
  ds_read_b128 v[56:59], v16 offset:26624
  ds_read_b128 v[60:63], v17 offset:26624
  s_add_u32 m0, s56, 49152
  s_nop 0
  buffer_load_dwordx4 v4, s[8:11], s55 offen lds
  s_add_u32 m0, s56, 50176
  s_nop 0
  buffer_load_dwordx4 v5, s[8:11], s55 offen lds
  s_add_u32 m0, s56, 51200
  s_add_u32 s60, s55, 16384
  buffer_load_dwordx4 v4, s[8:11], s60 offen lds
  s_add_u32 m0, s56, 52224
  s_add_u32 s60, s55, 16384
  buffer_load_dwordx4 v5, s[8:11], s60 offen lds
  s_add_u32 m0, s57, 49152
  s_nop 0
  buffer_load_dwordx4 v6, s[12:15], s55 offen lds
  s_add_u32 m0, s57, 50176
  s_nop 0
  buffer_load_dwordx4 v7, s[12:15], s55 offen lds
  s_waitcnt lgkmcnt(3)
  v_mfma_f32_16x16x32_bf16 v[64:67], v[20:23], v[48:51], v[64:67]
  v_mfma_f32_16x16x32_bf16 v[72:75], v[48:51], v[48:51], v[72:75]
  s_waitcnt lgkmcnt(2)
  v_mfma_f32_16x16x32_bf16 v[64:67], v[20:23], v[52:55], v[64:67]
  v_mfma_f32_16x16x32_bf16 v[72:75], v[52:55], v[52:55], v[72:75]
  s_waitcnt lgkmcnt(1)
  v_mfma_f32_16x16x32_bf16 v[68:71], v[20:23], v[56:59], v[68:71]
  v_mfma_f32_16x16x32_bf16 v[76:79], v[56:59], v[56:59], v[76:79]
  s_waitcnt lgkmcnt(0)
  v_mfma_f32_16x16x32_bf16 v[68:71], v[20:23], v[60:63], v[68:71]
  v_mfma_f32_16x16x32_bf16 v[76:79], v[60:63], v[60:63], v[76:79]
  s_waitcnt lgkmcnt(0)
  s_waitcnt vmcnt(12)
  s_barrier
  v_add_u32 v8, 4294893568, v8
  v_add_u32 v9, 4294893568, v9
  v_add_u32 v10, 4294893568, v10
  v_add_u32 v11, 4294893568, v11
  v_add_u32 v16, 4294893568, v16
  v_add_u32 v17, 4294893568, v17
  ds_read_b128 a[80:83], v8 offset:0
  ds_read_b128 a[84:87], v9 offset:0
  ds_read_b128 a[88:91], v10 offset:0
  ds_read_b128 a[92:95], v11 offset:0
  ds_read_b128 v[48:51], v16 offset:0
  ds_read_b128 v[52:55], v17 offset:0
  ds_read_b128 v[56:59], v16 offset:2048
  ds_read_b128 v[60:63], v17 offset:2048
  s_waitcnt lgkmcnt(3)
  v_mfma_f32_16x16x32_bf16 v[64:67], v[20:23], v[48:51], v[64:67]
  v_mfma_f32_16x16x32_bf16 v[72:75], v[48:51], v[48:51], v[72:75]
  s_waitcnt lgkmcnt(2)
  v_mfma_f32_16x16x32_bf16 v[64:67], v[20:23], v[52:55], v[64:67]
  v_mfma_f32_16x16x32_bf16 v[72:75], v[52:55], v[52:55], v[72:75]
  s_waitcnt lgkmcnt(1)
  v_mfma_f32_16x16x32_bf16 v[68:71], v[20:23], v[56:59], v[68:71]
  v_mfma_f32_16x16x32_bf16 v[76:79], v[56:59], v[56:59], v[76:79]
  s_waitcnt lgkmcnt(0)
  v_mfma_f32_16x16x32_bf16 v[68:71], v[20:23], v[60:63], v[68:71]
  v_mfma_f32_16x16x32_bf16 v[76:79], v[60:63], v[60:63], v[76:79]
  s_mul_i32 s5, s45, 3584
  s_add_u32 s5, s5, 122880
  s_lshl_b32 s6, s63, 7
  s_add_u32 s5, s5, s6
  v_add_u32 v42, s5, v41

  v_mov_b32 v80, 0
  v_mov_b32 v81, 0
  v_mov_b32 v82, 0
  v_mov_b32 v83, 0
  ds_read_b64_tr_b16 v[96:97], v42 offset:0
  ds_read_b64_tr_b16 v[98:99], v42 offset:896
  ds_read_b64_tr_b16 v[100:101], v42 offset:32
  ds_read_b64_tr_b16 v[102:103], v42 offset:928
  ds_read_b64_tr_b16 v[104:105], v42 offset:64
  ds_read_b64_tr_b16 v[106:107], v42 offset:960
  ds_read_b64_tr_b16 v[108:109], v42 offset:96
  ds_read_b64_tr_b16 v[110:111], v42 offset:992
  s_lshl_b32 s5, s45, 2
  s_add_u32 s5, s5, 155776
  s_lshl_b32 s6, s63, 11
  s_add_u32 s5, s5, s6
  v_lshlrev_b32 v88, 4, v1
  v_add_u32 v88, s5, v88
  s_waitcnt lgkmcnt(0)

  v_dot2c_f32_bf16 v80, s58, v96
  v_dot2c_f32_bf16 v80, s58, v97
  v_dot2c_f32_bf16 v80, s58, v98
  v_dot2c_f32_bf16 v80, s58, v99
  v_dot2c_f32_bf16 v81, s58, v100
  v_dot2c_f32_bf16 v81, s58, v101
  v_dot2c_f32_bf16 v81, s58, v102
  v_dot2c_f32_bf16 v81, s58, v103
  v_dot2c_f32_bf16 v82, s58, v104
  v_dot2c_f32_bf16 v82, s58, v105
  v_dot2c_f32_bf16 v82, s58, v106
  v_dot2c_f32_bf16 v82, s58, v107
  v_dot2c_f32_bf16 v83, s58, v108
  v_dot2c_f32_bf16 v83, s58, v109
  v_dot2c_f32_bf16 v83, s58, v110
  v_dot2c_f32_bf16 v83, s58, v111
  v_mov_b32 v84, v80
  v_mov_b32 v85, v81
  v_mov_b32 v86, v82
  v_mov_b32 v87, v83
  s_nop 1
  v_permlane32_swap_b32 v80, v84
  v_permlane32_swap_b32 v81, v85
  v_permlane32_swap_b32 v82, v86
  v_permlane32_swap_b32 v83, v87
  s_nop 1
  v_add_f32 v84, v80, v84
  ds_write_b32 v88, v84 offset:0
  v_add_f32 v85, v81, v85
  ds_write_b32 v88, v85 offset:512
  v_add_f32 v86, v82, v86
  ds_write_b32 v88, v86 offset:1024
  v_add_f32 v87, v83, v87
  ds_write_b32 v88, v87 offset:1536
LB_nocsjob:
  s_waitcnt lgkmcnt(0)
  s_waitcnt vmcnt(6)
  s_barrier
  ds_read_b128 a[96:99], v8 offset:24576
  ds_read_b128 a[100:103], v9 offset:24576
  ds_read_b128 a[104:107], v10 offset:24576
  ds_read_b128 a[108:111], v11 offset:24576
  ds_read_b128 v[48:51], v16 offset:24576
  ds_read_b128 v[52:55], v17 offset:24576
  ds_read_b128 v[56:59], v16 offset:26624
  ds_read_b128 v[60:63], v17 offset:26624
  s_add_u32 m0, s59, 86400
  s_nop 0
  buffer_load_dwordx4 v12, s[16:19], s73 offen lds
  s_add_u32 m0, s59, 87424
  s_nop 0
  buffer_load_dwordx4 v13, s[16:19], s73 offen lds
  s_add_u32 m0, s59, 88448
  s_nop 0
  buffer_load_dwordx4 v14, s[16:19], s73 offen lds
  s_add_u32 m0, s59, 89472
  s_nop 0
  buffer_load_dwordx4 v15, s[16:19], s73 offen lds
  s_waitcnt lgkmcnt(3)
  v_mfma_f32_16x16x32_bf16 v[64:67], v[20:23], v[48:51], v[64:67]
  v_mfma_f32_16x16x32_bf16 v[72:75], v[48:51], v[48:51], v[72:75]
  s_waitcnt lgkmcnt(2)
  v_mfma_f32_16x16x32_bf16 v[64:67], v[20:23], v[52:55], v[64:67]
  v_mfma_f32_16x16x32_bf16 v[72:75], v[52:55], v[52:55], v[72:75]
  s_waitcnt lgkmcnt(1)
  v_mfma_f32_16x16x32_bf16 v[68:71], v[20:23], v[56:59], v[68:71]
  v_mfma_f32_16x16x32_bf16 v[76:79], v[56:59], v[56:59], v[76:79]
  s_waitcnt lgkmcnt(0)
  v_mfma_f32_16x16x32_bf16 v[68:71], v[20:23], v[60:63], v[68:71]
  v_mfma_f32_16x16x32_bf16 v[76:79], v[60:63], v[60:63], v[76:79]
  s_waitcnt lgkmcnt(0)
  s_waitcnt vmcnt(4)
  s_barrier
  ds_read_b128 a[112:115], v8 offset:49152
  ds_read_b128 a[116:119], v9 offset:49152
  ds_read_b128 a[120:123], v10 offset:49152
  ds_read_b128 a[124:127], v11 offset:49152
  ds_read_b128 v[48:51], v16 offset:49152
  ds_read_b128 v[52:55], v17 offset:49152
  ds_read_b128 v[56:59], v16 offset:51200
  ds_read_b128 v[60:63], v17 offset:51200
  s_waitcnt lgkmcnt(3)
  v_mfma_f32_16x16x32_bf16 v[64:67], v[20:23], v[48:51], v[64:67]
  v_mfma_f32_16x16x32_bf16 v[72:75], v[48:51], v[48:51], v[72:75]
  s_waitcnt lgkmcnt(2)
  v_mfma_f32_16x16x32_bf16 v[64:67], v[20:23], v[52:55], v[64:67]
  v_mfma_f32_16x16x32_bf16 v[72:75], v[52:55], v[52:55], v[72:75]
  s_waitcnt lgkmcnt(1)
  v_mfma_f32_16x16x32_bf16 v[68:71], v[20:23], v[56:59], v[68:71]
  v_mfma_f32_16x16x32_bf16 v[76:79], v[56:59], v[56:59], v[76:79]
  s_waitcnt lgkmcnt(0)
  v_mfma_f32_16x16x32_bf16 v[68:71], v[20:23], v[60:63], v[68:71]
  v_mfma_f32_16x16x32_bf16 v[76:79], v[60:63], v[60:63], v[76:79]
  s_waitcnt lgkmcnt(0)
  v_and_b32 v36, 3, v0
  v_cmp_eq_u32 s[6:7], 1, v36
  v_cmp_eq_u32 vcc, 2, v36
  v_cmp_eq_u32 s[4:5], 3, v36
  s_nop 4

  v_cndmask_b32 v72, v72, v73, s[6:7]
  v_cndmask_b32 v72, v72, v74, vcc
  v_cndmask_b32 v72, v72, v75, s[4:5]

  v_cndmask_b32 v76, v76, v77, s[6:7]
  v_cndmask_b32 v76, v76, v78, vcc
  v_cndmask_b32 v76, v76, v79, s[4:5]

  v_lshrrev_b32 v36, 4, v0
  v_bfe_u32 v37, v0, 2, 2
  v_cmp_eq_u32 s[6:7], v36, v37

  v_mov_b32 v80, v64
  v_mov_b32 v81, v72
  v_mul_f32 v80, 0x3b000000, v80
  v_mul_f32 v81, 0x3b000000, v81
  v_fma_f32 v81, -v80, v80, v81
  v_max_f32 v81, 0, v81
  v_cvt_pk_bf16_f32 v84, v80, v81
  v_lshlrev_b32 v80, 16, v84
  v_and_b32 v81, 0xffff0000, v84
  v_add_f32 v81, 0x3727c5ac, v81
  v_cvt_pk_bf16_f32 v84, v81, v81
  v_and_b32 v81, 0xffff0000, v84
  v_sqrt_f32 v81, v81
  s_nop 0
  v_cvt_pk_bf16_f32 v84, v81, v81
  v_and_b32 v81, 0xffff0000, v84
  v_rcp_f32 v81, v81
  s_nop 0

  v_mov_b32 v82, v68
  v_mov_b32 v83, v76
  v_mul_f32 v82, 0x3b000000, v82
  v_mul_f32 v83, 0x3b000000, v83
  v_fma_f32 v83, -v82, v82, v83
  v_max_f32 v83, 0, v83
  v_cvt_pk_bf16_f32 v84, v82, v83
  v_lshlrev_b32 v82, 16, v84
  v_and_b32 v83, 0xffff0000, v84
  v_add_f32 v83, 0x3727c5ac, v83
  v_cvt_pk_bf16_f32 v84, v83, v83
  v_and_b32 v83, 0xffff0000, v84
  v_sqrt_f32 v83, v83
  s_nop 0
  v_cvt_pk_bf16_f32 v84, v83, v83
  v_and_b32 v83, 0xffff0000, v84
  v_rcp_f32 v83, v83
  s_nop 0

  s_lshl_b32 s5, s45, 5
  v_and_b32 v36, 15, v0
  v_add_u32 v36, s5, v36
  v_lshlrev_b32 v36, 3, v36
  v_add_u32 v37, 153728, v36
  s_mov_b64 exec, s[6:7]
  ds_write_b64 v37, v[80:81]
  ds_write_b64 v37, v[82:83] offset:128
  s_cmp_lg_u32 s47, 0
  s_cbranch_scc1 LB_nostat
  s_lshl_b32 s5, s46, 10
  s_add_u32 s5, s5, 14417920
  buffer_store_dwordx2 v[80:81], v36, s[20:23], s5 offen sc1
  buffer_store_dwordx2 v[82:83], v36, s[20:23], s5 offen offset:128 sc1

LB_nostat:
  s_mov_b64 exec, -1
  s_lshl_b32 s5, s45, 5
  v_add_u32 v36, s5, v3
  v_lshlrev_b32 v36, 3, v36
  v_add_u32 v36, 153728, v36
  s_waitcnt lgkmcnt(0)
  ds_read_b64 v[44:45], v36

  v_mov_b32 v48, 0
  v_mov_b32 v49, 0
  v_mov_b32 v50, 0
  v_mov_b32 v51, 0
  v_mov_b32 v52, 0
  v_mov_b32 v53, 0
  v_mov_b32 v54, 0
  v_mov_b32 v55, 0
  v_mov_b32 v56, 0
  v_mov_b32 v57, 0
  v_mov_b32 v58, 0
  v_mov_b32 v59, 0
  v_mov_b32 v60, 0
  v_mov_b32 v61, 0
  v_mov_b32 v62, 0
  v_mov_b32 v63, 0
  v_mov_b32 v64, 0
  v_mov_b32 v65, 0
  v_mov_b32 v66, 0
  v_mov_b32 v67, 0
  v_mov_b32 v68, 0
  v_mov_b32 v69, 0
  v_mov_b32 v70, 0
  v_mov_b32 v71, 0
  v_mov_b32 v72, 0
  v_mov_b32 v73, 0
  v_mov_b32 v74, 0
  v_mov_b32 v75, 0
  v_mov_b32 v76, 0
  v_mov_b32 v77, 0
  v_mov_b32 v78, 0
  v_mov_b32 v79, 0
  v_mov_b32 v80, 0
  v_mov_b32 v81, 0
  v_mov_b32 v82, 0
  v_mov_b32 v83, 0
  v_mov_b32 v84, 0
  v_mov_b32 v85, 0
  v_mov_b32 v86, 0
  v_mov_b32 v87, 0
  v_mov_b32 v88, 0
  v_mov_b32 v89, 0
  v_mov_b32 v90, 0
  v_mov_b32 v91, 0
  v_mov_b32 v92, 0
  v_mov_b32 v93, 0
  v_mov_b32 v94, 0
  v_mov_b32 v95, 0
  v_mov_b32 v96, 0
  v_mov_b32 v97, 0
  v_mov_b32 v98, 0
  v_mov_b32 v99, 0
  v_mov_b32 v100, 0
  v_mov_b32 v101, 0
  v_mov_b32 v102, 0
  v_mov_b32 v103, 0
  v_mov_b32 v104, 0
  v_mov_b32 v105, 0
  v_mov_b32 v106, 0
  v_mov_b32 v107, 0
  v_mov_b32 v108, 0
  v_mov_b32 v109, 0
  v_mov_b32 v110, 0
  v_mov_b32 v111, 0
  v_mov_b32 v112, 0
  v_mov_b32 v113, 0
  v_mov_b32 v114, 0
  v_mov_b32 v115, 0
  v_mov_b32 v116, 0
  v_mov_b32 v117, 0
  v_mov_b32 v118, 0
  v_mov_b32 v119, 0
  v_mov_b32 v120, 0
  v_mov_b32 v121, 0
  v_mov_b32 v122, 0
  v_mov_b32 v123, 0
  v_mov_b32 v124, 0
  v_mov_b32 v125, 0
  v_mov_b32 v126, 0
  v_mov_b32 v127, 0
  s_waitcnt lgkmcnt(0)
  s_setprio 1
  s_barrier
  v_add_u32 v42, 122880, v41
  ds_read_b64_tr_b16 v[20:21], v42 offset:64
  ds_read_b64_tr_b16 v[22:23], v42 offset:960
  ds_read_b64_tr_b16 v[24:25], v42 offset:96
  ds_read_b64_tr_b16 v[26:27], v42 offset:992
  ds_read_b64_tr_b16 v[28:29], v42 offset:128
  ds_read_b64_tr_b16 v[30:31], v42 offset:1024
  ds_read_b64_tr_b16 v[32:33], v42 offset:160
  ds_read_b64_tr_b16 v[34:35], v42 offset:1056
  s_waitcnt lgkmcnt(6)
  v_mfma_f32_32x32x16_bf16 v[48:63], v[20:23], a[0:3], v[48:63]
  s_add_u32 m0, s59, 0
  s_nop 0
  buffer_load_dwordx4 v12, s[16:19], s74 offen lds
  ds_read_b64_tr_b16 v[20:21], v42 offset:192
  ds_read_b64_tr_b16 v[22:23], v42 offset:1088
  s_waitcnt lgkmcnt(6)
  v_mfma_f32_32x32x16_bf16 v[64:79], v[24:27], a[0:3], v[64:79]
  ds_read_b64_tr_b16 v[24:25], v42 offset:3648
  ds_read_b64_tr_b16 v[26:27], v42 offset:4544
  s_waitcnt lgkmcnt(6)
  v_mfma_f32_32x32x16_bf16 v[80:95], v[28:31], a[0:3], v[80:95]
  s_add_u32 m0, s59, 1024
  s_nop 0
  buffer_load_dwordx4 v13, s[16:19], s74 offen lds
  ds_read_b64_tr_b16 v[28:29], v42 offset:3680
  ds_read_b64_tr_b16 v[30:31], v42 offset:4576
  s_waitcnt lgkmcnt(6)
  v_mfma_f32_32x32x16_bf16 v[96:111], v[32:35], a[0:3], v[96:111]
  ds_read_b64_tr_b16 v[32:33], v42 offset:3712
  ds_read_b64_tr_b16 v[34:35], v42 offset:4608
  s_waitcnt lgkmcnt(6)
  v_mfma_f32_32x32x16_bf16 v[112:127], v[20:23], a[0:3], v[112:127]
  s_add_u32 m0, s59, 2048
  s_nop 0
  buffer_load_dwordx4 v14, s[16:19], s74 offen lds
  ds_read_b64_tr_b16 v[20:21], v42 offset:3744
  ds_read_b64_tr_b16 v[22:23], v42 offset:4640
  s_waitcnt lgkmcnt(6)
  v_mfma_f32_32x32x16_bf16 v[48:63], v[24:27], a[4:7], v[48:63]
  ds_read_b64_tr_b16 v[24:25], v42 offset:3776
  ds_read_b64_tr_b16 v[26:27], v42 offset:4672
  s_waitcnt lgkmcnt(6)
  v_mfma_f32_32x32x16_bf16 v[64:79], v[28:31], a[4:7], v[64:79]
  s_add_u32 m0, s59, 3072
  s_nop 0
  buffer_load_dwordx4 v15, s[16:19], s74 offen lds
  ds_read_b64_tr_b16 v[28:29], v42 offset:7232
  ds_read_b64_tr_b16 v[30:31], v42 offset:8128
  s_waitcnt lgkmcnt(6)
  v_mfma_f32_32x32x16_bf16 v[80:95], v[32:35], a[4:7], v[80:95]
  ds_read_b64_tr_b16 v[32:33], v42 offset:7264
  ds_read_b64_tr_b16 v[34:35], v42 offset:8160
  s_waitcnt lgkmcnt(6)
  v_mfma_f32_32x32x16_bf16 v[96:111], v[20:23], a[4:7], v[96:111]
  s_add_u32 m0, s59, 28800
  s_nop 0
  buffer_load_dwordx4 v12, s[16:19], s75 offen lds
  ds_read_b64_tr_b16 v[20:21], v42 offset:7296
  ds_read_b64_tr_b16 v[22:23], v42 offset:8192
  s_waitcnt lgkmcnt(6)
  v_mfma_f32_32x32x16_bf16 v[112:127], v[24:27], a[4:7], v[112:127]
  s_add_u32 m0, s59, 29824
  s_nop 0
  buffer_load_dwordx4 v13, s[16:19], s75 offen lds
  s_add_u32 m0, s59, 30848
  s_nop 0
  buffer_load_dwordx4 v14, s[16:19], s75 offen lds
  s_add_u32 m0, s59, 31872
  s_nop 0
  buffer_load_dwordx4 v15, s[16:19], s75 offen lds
  s_waitcnt vmcnt(8)
  s_barrier
  ds_read_b64_tr_b16 v[24:25], v42 offset:7328
  ds_read_b64_tr_b16 v[26:27], v42 offset:8224
  s_waitcnt lgkmcnt(6)
  v_mfma_f32_32x32x16_bf16 v[48:63], v[28:31], a[8:11], v[48:63]
  s_add_u32 m0, s59, 57600
  s_nop 0
  buffer_load_dwordx4 v12, s[16:19], s76 offen lds
  ds_read_b64_tr_b16 v[28:29], v42 offset:7360
  ds_read_b64_tr_b16 v[30:31], v42 offset:8256
  s_waitcnt lgkmcnt(6)
  v_mfma_f32_32x32x16_bf16 v[64:79], v[32:35], a[8:11], v[64:79]
  ds_read_b64_tr_b16 v[32:33], v42 offset:10816
  ds_read_b64_tr_b16 v[34:35], v42 offset:11712
  s_waitcnt lgkmcnt(6)
  v_mfma_f32_32x32x16_bf16 v[80:95], v[20:23], a[8:11], v[80:95]
  s_add_u32 m0, s59, 58624
  s_nop 0
  buffer_load_dwordx4 v13, s[16:19], s76 offen lds
  ds_read_b64_tr_b16 v[20:21], v42 offset:10848
  ds_read_b64_tr_b16 v[22:23], v42 offset:11744
  s_waitcnt lgkmcnt(6)
  v_mfma_f32_32x32x16_bf16 v[96:111], v[24:27], a[8:11], v[96:111]
  ds_read_b64_tr_b16 v[24:25], v42 offset:10880
  ds_read_b64_tr_b16 v[26:27], v42 offset:11776
  s_waitcnt lgkmcnt(6)
  v_mfma_f32_32x32x16_bf16 v[112:127], v[28:31], a[8:11], v[112:127]
  s_add_u32 m0, s59, 59648
  s_nop 0
  buffer_load_dwordx4 v14, s[16:19], s76 offen lds
  ds_read_b64_tr_b16 v[28:29], v42 offset:10912
  ds_read_b64_tr_b16 v[30:31], v42 offset:11808
  s_waitcnt lgkmcnt(6)
  v_mfma_f32_32x32x16_bf16 v[48:63], v[32:35], a[12:15], v[48:63]
  ds_read_b64_tr_b16 v[32:33], v42 offset:10944
  ds_read_b64_tr_b16 v[34:35], v42 offset:11840
  s_waitcnt lgkmcnt(6)
  v_mfma_f32_32x32x16_bf16 v[64:79], v[20:23], a[12:15], v[64:79]
  s_add_u32 m0, s59, 60672
  s_nop 0
  buffer_load_dwordx4 v15, s[16:19], s76 offen lds
  v_add_u32 v42, 86400, v41
  ds_read_b64_tr_b16 v[20:21], v42 offset:64
  ds_read_b64_tr_b16 v[22:23], v42 offset:960
  s_waitcnt lgkmcnt(6)
  v_mfma_f32_32x32x16_bf16 v[80:95], v[24:27], a[12:15], v[80:95]
  ds_read_b64_tr_b16 v[24:25], v42 offset:96
  ds_read_b64_tr_b16 v[26:27], v42 offset:992
  s_waitcnt lgkmcnt(6)
  v_mfma_f32_32x32x16_bf16 v[96:111], v[28:31], a[12:15], v[96:111]
  ds_read_b64_tr_b16 v[28:29], v42 offset:128
  ds_read_b64_tr_b16 v[30:31], v42 offset:1024
  s_waitcnt lgkmcnt(6)
  v_mfma_f32_32x32x16_bf16 v[112:127], v[32:35], a[12:15], v[112:127]
  ds_read_b64_tr_b16 v[32:33], v42 offset:160
  ds_read_b64_tr_b16 v[34:35], v42 offset:1056
  s_waitcnt lgkmcnt(6)
  v_mfma_f32_32x32x16_bf16 v[48:63], v[20:23], a[16:19], v[48:63]
  ds_read_b64_tr_b16 v[20:21], v42 offset:192
  ds_read_b64_tr_b16 v[22:23], v42 offset:1088
  s_waitcnt lgkmcnt(6)
  v_mfma_f32_32x32x16_bf16 v[64:79], v[24:27], a[16:19], v[64:79]
  ds_read_b64_tr_b16 v[24:25], v42 offset:3648
  ds_read_b64_tr_b16 v[26:27], v42 offset:4544
  s_waitcnt lgkmcnt(6)
  v_mfma_f32_32x32x16_bf16 v[80:95], v[28:31], a[16:19], v[80:95]
  ds_read_b64_tr_b16 v[28:29], v42 offset:3680
  ds_read_b64_tr_b16 v[30:31], v42 offset:4576
  s_waitcnt lgkmcnt(6)
  v_mfma_f32_32x32x16_bf16 v[96:111], v[32:35], a[16:19], v[96:111]
  ds_read_b64_tr_b16 v[32:33], v42 offset:3712
  ds_read_b64_tr_b16 v[34:35], v42 offset:4608
  s_waitcnt lgkmcnt(6)
  v_mfma_f32_32x32x16_bf16 v[112:127], v[20:23], a[16:19], v[112:127]
  ds_read_b64_tr_b16 v[20:21], v42 offset:3744
  ds_read_b64_tr_b16 v[22:23], v42 offset:4640
  s_waitcnt lgkmcnt(6)
  v_mfma_f32_32x32x16_bf16 v[48:63], v[24:27], a[20:23], v[48:63]
  ds_read_b64_tr_b16 v[24:25], v42 offset:3776
  ds_read_b64_tr_b16 v[26:27], v42 offset:4672
  s_waitcnt lgkmcnt(6)
  v_mfma_f32_32x32x16_bf16 v[64:79], v[28:31], a[20:23], v[64:79]
  ds_read_b64_tr_b16 v[28:29], v42 offset:7232
  ds_read_b64_tr_b16 v[30:31], v42 offset:8128
  s_waitcnt lgkmcnt(6)
  v_mfma_f32_32x32x16_bf16 v[80:95], v[32:35], a[20:23], v[80:95]
  ds_read_b64_tr_b16 v[32:33], v42 offset:7264
  ds_read_b64_tr_b16 v[34:35], v42 offset:8160
  s_waitcnt lgkmcnt(6)
  v_mfma_f32_32x32x16_bf16 v[96:111], v[20:23], a[20:23], v[96:111]
  ds_read_b64_tr_b16 v[20:21], v42 offset:7296
  ds_read_b64_tr_b16 v[22:23], v42 offset:8192
  s_waitcnt lgkmcnt(6)
  v_mfma_f32_32x32x16_bf16 v[112:127], v[24:27], a[20:23], v[112:127]
  s_waitcnt vmcnt(8)
  s_barrier
  ds_read_b64_tr_b16 v[24:25], v42 offset:7328
  ds_read_b64_tr_b16 v[26:27], v42 offset:8224
  s_waitcnt lgkmcnt(6)
  v_mfma_f32_32x32x16_bf16 v[48:63], v[28:31], a[24:27], v[48:63]
  ds_read_b64_tr_b16 v[28:29], v42 offset:7360
  ds_read_b64_tr_b16 v[30:31], v42 offset:8256
  s_waitcnt lgkmcnt(6)
  v_mfma_f32_32x32x16_bf16 v[64:79], v[32:35], a[24:27], v[64:79]
  ds_read_b64_tr_b16 v[32:33], v42 offset:10816
  ds_read_b64_tr_b16 v[34:35], v42 offset:11712
  s_waitcnt lgkmcnt(6)
  v_mfma_f32_32x32x16_bf16 v[80:95], v[20:23], a[24:27], v[80:95]
  ds_read_b64_tr_b16 v[20:21], v42 offset:10848
  ds_read_b64_tr_b16 v[22:23], v42 offset:11744
  s_waitcnt lgkmcnt(6)
  v_mfma_f32_32x32x16_bf16 v[96:111], v[24:27], a[24:27], v[96:111]
  ds_read_b64_tr_b16 v[24:25], v42 offset:10880
  ds_read_b64_tr_b16 v[26:27], v42 offset:11776
  s_waitcnt lgkmcnt(6)
  v_mfma_f32_32x32x16_bf16 v[112:127], v[28:31], a[24:27], v[112:127]
  ds_read_b64_tr_b16 v[28:29], v42 offset:10912
  ds_read_b64_tr_b16 v[30:31], v42 offset:11808
  s_waitcnt lgkmcnt(6)
  v_mfma_f32_32x32x16_bf16 v[48:63], v[32:35], a[28:31], v[48:63]
  ds_read_b64_tr_b16 v[32:33], v42 offset:10944
  ds_read_b64_tr_b16 v[34:35], v42 offset:11840
  s_waitcnt lgkmcnt(6)
  v_mfma_f32_32x32x16_bf16 v[64:79], v[20:23], a[28:31], v[64:79]
  v_add_u32 v42, 0, v41
  ds_read_b64_tr_b16 v[20:21], v42 offset:64
  ds_read_b64_tr_b16 v[22:23], v42 offset:960
  s_waitcnt lgkmcnt(6)
  v_mfma_f32_32x32x16_bf16 v[80:95], v[24:27], a[28:31], v[80:95]
  ds_read_b64_tr_b16 v[24:25], v42 offset:96
  ds_read_b64_tr_b16 v[26:27], v42 offset:992
  s_waitcnt lgkmcnt(6)
  v_mfma_f32_32x32x16_bf16 v[96:111], v[28:31], a[28:31], v[96:111]
  ds_read_b64_tr_b16 v[28:29], v42 offset:128
  ds_read_b64_tr_b16 v[30:31], v42 offset:1024
  s_waitcnt lgkmcnt(6)
  v_mfma_f32_32x32x16_bf16 v[112:127], v[32:35], a[28:31], v[112:127]
  ds_read_b64_tr_b16 v[32:33], v42 offset:160
  ds_read_b64_tr_b16 v[34:35], v42 offset:1056
  s_waitcnt lgkmcnt(6)
  v_mfma_f32_32x32x16_bf16 v[48:63], v[20:23], a[32:35], v[48:63]
  ds_read_b64_tr_b16 v[20:21], v42 offset:192
  ds_read_b64_tr_b16 v[22:23], v42 offset:1088
  s_waitcnt lgkmcnt(6)
  v_mfma_f32_32x32x16_bf16 v[64:79], v[24:27], a[32:35], v[64:79]
  ds_read_b64_tr_b16 v[24:25], v42 offset:3648
  ds_read_b64_tr_b16 v[26:27], v42 offset:4544
  s_waitcnt lgkmcnt(6)
  v_mfma_f32_32x32x16_bf16 v[80:95], v[28:31], a[32:35], v[80:95]
  ds_read_b64_tr_b16 v[28:29], v42 offset:3680
  ds_read_b64_tr_b16 v[30:31], v42 offset:4576
  s_waitcnt lgkmcnt(6)
  v_mfma_f32_32x32x16_bf16 v[96:111], v[32:35], a[32:35], v[96:111]
  ds_read_b64_tr_b16 v[32:33], v42 offset:3712
  ds_read_b64_tr_b16 v[34:35], v42 offset:4608
  s_waitcnt lgkmcnt(6)
  v_mfma_f32_32x32x16_bf16 v[112:127], v[20:23], a[32:35], v[112:127]
  ds_read_b64_tr_b16 v[20:21], v42 offset:3744
  ds_read_b64_tr_b16 v[22:23], v42 offset:4640
  s_waitcnt lgkmcnt(6)
  v_mfma_f32_32x32x16_bf16 v[48:63], v[24:27], a[36:39], v[48:63]
  ds_read_b64_tr_b16 v[24:25], v42 offset:3776
  ds_read_b64_tr_b16 v[26:27], v42 offset:4672
  s_waitcnt lgkmcnt(6)
  v_mfma_f32_32x32x16_bf16 v[64:79], v[28:31], a[36:39], v[64:79]
  ds_read_b64_tr_b16 v[28:29], v42 offset:7232
  ds_read_b64_tr_b16 v[30:31], v42 offset:8128
  s_waitcnt lgkmcnt(6)
  v_mfma_f32_32x32x16_bf16 v[80:95], v[32:35], a[36:39], v[80:95]
  ds_read_b64_tr_b16 v[32:33], v42 offset:7264
  ds_read_b64_tr_b16 v[34:35], v42 offset:8160
  s_waitcnt lgkmcnt(6)
  v_mfma_f32_32x32x16_bf16 v[96:111], v[20:23], a[36:39], v[96:111]
  ds_read_b64_tr_b16 v[20:21], v42 offset:7296
  ds_read_b64_tr_b16 v[22:23], v42 offset:8192
  s_waitcnt lgkmcnt(6)
  v_mfma_f32_32x32x16_bf16 v[112:127], v[24:27], a[36:39], v[112:127]
  s_waitcnt vmcnt(4)
  s_barrier
  ds_read_b64_tr_b16 v[24:25], v42 offset:7328
  ds_read_b64_tr_b16 v[26:27], v42 offset:8224
  s_waitcnt lgkmcnt(6)
  v_mfma_f32_32x32x16_bf16 v[48:63], v[28:31], a[40:43], v[48:63]
  s_add_u32 m0, s59, 122880
  s_nop 0
  buffer_load_dwordx4 v12, s[16:19], s77 offen lds
  ds_read_b64_tr_b16 v[28:29], v42 offset:7360
  ds_read_b64_tr_b16 v[30:31], v42 offset:8256
  s_waitcnt lgkmcnt(6)
  v_mfma_f32_32x32x16_bf16 v[64:79], v[32:35], a[40:43], v[64:79]
  ds_read_b64_tr_b16 v[32:33], v42 offset:10816
  ds_read_b64_tr_b16 v[34:35], v42 offset:11712
  s_waitcnt lgkmcnt(6)
  v_mfma_f32_32x32x16_bf16 v[80:95], v[20:23], a[40:43], v[80:95]
  s_add_u32 m0, s59, 123904
  s_nop 0
  buffer_load_dwordx4 v13, s[16:19], s77 offen lds
  ds_read_b64_tr_b16 v[20:21], v42 offset:10848
  ds_read_b64_tr_b16 v[22:23], v42 offset:11744
  s_waitcnt lgkmcnt(6)
  v_mfma_f32_32x32x16_bf16 v[96:111], v[24:27], a[40:43], v[96:111]
  ds_read_b64_tr_b16 v[24:25], v42 offset:10880
  ds_read_b64_tr_b16 v[26:27], v42 offset:11776
  s_waitcnt lgkmcnt(6)
  v_mfma_f32_32x32x16_bf16 v[112:127], v[28:31], a[40:43], v[112:127]
  s_add_u32 m0, s59, 124928
  s_nop 0
  buffer_load_dwordx4 v14, s[16:19], s77 offen lds
  ds_read_b64_tr_b16 v[28:29], v42 offset:10912
  ds_read_b64_tr_b16 v[30:31], v42 offset:11808
  s_waitcnt lgkmcnt(6)
  v_mfma_f32_32x32x16_bf16 v[48:63], v[32:35], a[44:47], v[48:63]
  ds_read_b64_tr_b16 v[32:33], v42 offset:10944
  ds_read_b64_tr_b16 v[34:35], v42 offset:11840
  s_waitcnt lgkmcnt(6)
  v_mfma_f32_32x32x16_bf16 v[64:79], v[20:23], a[44:47], v[64:79]
  s_add_u32 m0, s59, 125952
  s_nop 0
  buffer_load_dwordx4 v15, s[16:19], s77 offen lds
  v_add_u32 v42, 28800, v41
  ds_read_b64_tr_b16 v[20:21], v42 offset:64
  ds_read_b64_tr_b16 v[22:23], v42 offset:960
  s_waitcnt lgkmcnt(6)
  v_mfma_f32_32x32x16_bf16 v[80:95], v[24:27], a[44:47], v[80:95]
  ds_read_b64_tr_b16 v[24:25], v42 offset:96
  ds_read_b64_tr_b16 v[26:27], v42 offset:992
  s_waitcnt lgkmcnt(6)
  v_mfma_f32_32x32x16_bf16 v[96:111], v[28:31], a[44:47], v[96:111]
  ds_read_b64_tr_b16 v[28:29], v42 offset:128
  ds_read_b64_tr_b16 v[30:31], v42 offset:1024
  s_waitcnt lgkmcnt(6)
  v_mfma_f32_32x32x16_bf16 v[112:127], v[32:35], a[44:47], v[112:127]
  ds_read_b64_tr_b16 v[32:33], v42 offset:160
  ds_read_b64_tr_b16 v[34:35], v42 offset:1056
  s_waitcnt lgkmcnt(6)
  v_mfma_f32_32x32x16_bf16 v[48:63], v[20:23], a[48:51], v[48:63]
  ds_read_b64_tr_b16 v[20:21], v42 offset:192
  ds_read_b64_tr_b16 v[22:23], v42 offset:1088
  s_waitcnt lgkmcnt(6)
  v_mfma_f32_32x32x16_bf16 v[64:79], v[24:27], a[48:51], v[64:79]
  ds_read_b64_tr_b16 v[24:25], v42 offset:3648
  ds_read_b64_tr_b16 v[26:27], v42 offset:4544
  s_waitcnt lgkmcnt(6)
  v_mfma_f32_32x32x16_bf16 v[80:95], v[28:31], a[48:51], v[80:95]
  ds_read_b64_tr_b16 v[28:29], v42 offset:3680
  ds_read_b64_tr_b16 v[30:31], v42 offset:4576
  s_waitcnt lgkmcnt(6)
  v_mfma_f32_32x32x16_bf16 v[96:111], v[32:35], a[48:51], v[96:111]
  ds_read_b64_tr_b16 v[32:33], v42 offset:3712
  ds_read_b64_tr_b16 v[34:35], v42 offset:4608
  s_waitcnt lgkmcnt(6)
  v_mfma_f32_32x32x16_bf16 v[112:127], v[20:23], a[48:51], v[112:127]
  ds_read_b64_tr_b16 v[20:21], v42 offset:3744
  ds_read_b64_tr_b16 v[22:23], v42 offset:4640
  s_waitcnt lgkmcnt(6)
  v_mfma_f32_32x32x16_bf16 v[48:63], v[24:27], a[52:55], v[48:63]
  ds_read_b64_tr_b16 v[24:25], v42 offset:3776
  ds_read_b64_tr_b16 v[26:27], v42 offset:4672
  s_waitcnt lgkmcnt(6)
  v_mfma_f32_32x32x16_bf16 v[64:79], v[28:31], a[52:55], v[64:79]
  ds_read_b64_tr_b16 v[28:29], v42 offset:7232
  ds_read_b64_tr_b16 v[30:31], v42 offset:8128
  s_waitcnt lgkmcnt(6)
  v_mfma_f32_32x32x16_bf16 v[80:95], v[32:35], a[52:55], v[80:95]
  ds_read_b64_tr_b16 v[32:33], v42 offset:7264
  ds_read_b64_tr_b16 v[34:35], v42 offset:8160
  s_waitcnt lgkmcnt(6)
  v_mfma_f32_32x32x16_bf16 v[96:111], v[20:23], a[52:55], v[96:111]
  ds_read_b64_tr_b16 v[20:21], v42 offset:7296
  ds_read_b64_tr_b16 v[22:23], v42 offset:8192
  s_waitcnt lgkmcnt(6)
  v_mfma_f32_32x32x16_bf16 v[112:127], v[24:27], a[52:55], v[112:127]
  s_waitcnt vmcnt(4)
  s_barrier
  ds_read_b64_tr_b16 v[24:25], v42 offset:7328
  ds_read_b64_tr_b16 v[26:27], v42 offset:8224
  s_waitcnt lgkmcnt(6)
  v_mfma_f32_32x32x16_bf16 v[48:63], v[28:31], a[56:59], v[48:63]
  s_add_u32 m0, s59, 86400
  s_nop 0
  buffer_load_dwordx4 v12, s[16:19], s78 offen lds
  ds_read_b64_tr_b16 v[28:29], v42 offset:7360
  ds_read_b64_tr_b16 v[30:31], v42 offset:8256
  s_waitcnt lgkmcnt(6)
  v_mfma_f32_32x32x16_bf16 v[64:79], v[32:35], a[56:59], v[64:79]
  ds_read_b64_tr_b16 v[32:33], v42 offset:10816
  ds_read_b64_tr_b16 v[34:35], v42 offset:11712
  s_waitcnt lgkmcnt(6)
  v_mfma_f32_32x32x16_bf16 v[80:95], v[20:23], a[56:59], v[80:95]
  s_add_u32 m0, s59, 87424
  s_nop 0
  buffer_load_dwordx4 v13, s[16:19], s78 offen lds
  ds_read_b64_tr_b16 v[20:21], v42 offset:10848
  ds_read_b64_tr_b16 v[22:23], v42 offset:11744
  s_waitcnt lgkmcnt(6)
  v_mfma_f32_32x32x16_bf16 v[96:111], v[24:27], a[56:59], v[96:111]
  ds_read_b64_tr_b16 v[24:25], v42 offset:10880
  ds_read_b64_tr_b16 v[26:27], v42 offset:11776
  s_waitcnt lgkmcnt(6)
  v_mfma_f32_32x32x16_bf16 v[112:127], v[28:31], a[56:59], v[112:127]
  s_add_u32 m0, s59, 88448
  s_nop 0
  buffer_load_dwordx4 v14, s[16:19], s78 offen lds
  ds_read_b64_tr_b16 v[28:29], v42 offset:10912
  ds_read_b64_tr_b16 v[30:31], v42 offset:11808
  s_waitcnt lgkmcnt(6)
  v_mfma_f32_32x32x16_bf16 v[48:63], v[32:35], a[60:63], v[48:63]
  ds_read_b64_tr_b16 v[32:33], v42 offset:10944
  ds_read_b64_tr_b16 v[34:35], v42 offset:11840
  s_waitcnt lgkmcnt(6)
  v_mfma_f32_32x32x16_bf16 v[64:79], v[20:23], a[60:63], v[64:79]
  s_add_u32 m0, s59, 89472
  s_nop 0
  buffer_load_dwordx4 v15, s[16:19], s78 offen lds
  v_add_u32 v42, 57600, v41
  ds_read_b64_tr_b16 v[20:21], v42 offset:64
  ds_read_b64_tr_b16 v[22:23], v42 offset:960
  s_waitcnt lgkmcnt(6)
  v_mfma_f32_32x32x16_bf16 v[80:95], v[24:27], a[60:63], v[80:95]
  ds_read_b64_tr_b16 v[24:25], v42 offset:96
  ds_read_b64_tr_b16 v[26:27], v42 offset:992
  s_waitcnt lgkmcnt(6)
  v_mfma_f32_32x32x16_bf16 v[96:111], v[28:31], a[60:63], v[96:111]
  ds_read_b64_tr_b16 v[28:29], v42 offset:128
  ds_read_b64_tr_b16 v[30:31], v42 offset:1024
  s_waitcnt lgkmcnt(6)
  v_mfma_f32_32x32x16_bf16 v[112:127], v[32:35], a[60:63], v[112:127]
  ds_read_b64_tr_b16 v[32:33], v42 offset:160
  ds_read_b64_tr_b16 v[34:35], v42 offset:1056
  s_waitcnt lgkmcnt(6)
  v_mfma_f32_32x32x16_bf16 v[48:63], v[20:23], a[64:67], v[48:63]
  ds_read_b64_tr_b16 v[20:21], v42 offset:192
  ds_read_b64_tr_b16 v[22:23], v42 offset:1088
  s_waitcnt lgkmcnt(6)
  v_mfma_f32_32x32x16_bf16 v[64:79], v[24:27], a[64:67], v[64:79]
  ds_read_b64_tr_b16 v[24:25], v42 offset:3648
  ds_read_b64_tr_b16 v[26:27], v42 offset:4544
  s_waitcnt lgkmcnt(6)
  v_mfma_f32_32x32x16_bf16 v[80:95], v[28:31], a[64:67], v[80:95]
  ds_read_b64_tr_b16 v[28:29], v42 offset:3680
  ds_read_b64_tr_b16 v[30:31], v42 offset:4576
  s_waitcnt lgkmcnt(6)
  v_mfma_f32_32x32x16_bf16 v[96:111], v[32:35], a[64:67], v[96:111]
  ds_read_b64_tr_b16 v[32:33], v42 offset:3712
  ds_read_b64_tr_b16 v[34:35], v42 offset:4608
  s_waitcnt lgkmcnt(6)
  v_mfma_f32_32x32x16_bf16 v[112:127], v[20:23], a[64:67], v[112:127]
  ds_read_b64_tr_b16 v[20:21], v42 offset:3744
  ds_read_b64_tr_b16 v[22:23], v42 offset:4640
  s_waitcnt lgkmcnt(6)
  v_mfma_f32_32x32x16_bf16 v[48:63], v[24:27], a[68:71], v[48:63]
  ds_read_b64_tr_b16 v[24:25], v42 offset:3776
  ds_read_b64_tr_b16 v[26:27], v42 offset:4672
  s_waitcnt lgkmcnt(6)
  v_mfma_f32_32x32x16_bf16 v[64:79], v[28:31], a[68:71], v[64:79]
  ds_read_b64_tr_b16 v[28:29], v42 offset:7232
  ds_read_b64_tr_b16 v[30:31], v42 offset:8128
  s_waitcnt lgkmcnt(6)
  v_mfma_f32_32x32x16_bf16 v[80:95], v[32:35], a[68:71], v[80:95]
  ds_read_b64_tr_b16 v[32:33], v42 offset:7264
  ds_read_b64_tr_b16 v[34:35], v42 offset:8160
  s_waitcnt lgkmcnt(6)
  v_mfma_f32_32x32x16_bf16 v[96:111], v[20:23], a[68:71], v[96:111]
  ds_read_b64_tr_b16 v[20:21], v42 offset:7296
  ds_read_b64_tr_b16 v[22:23], v42 offset:8192
  s_waitcnt lgkmcnt(6)
  v_mfma_f32_32x32x16_bf16 v[112:127], v[24:27], a[68:71], v[112:127]
  s_waitcnt vmcnt(4)
  s_barrier
  ds_read_b64_tr_b16 v[24:25], v42 offset:7328
  ds_read_b64_tr_b16 v[26:27], v42 offset:8224
  s_waitcnt lgkmcnt(6)
  v_mfma_f32_32x32x16_bf16 v[48:63], v[28:31], a[72:75], v[48:63]
  s_add_u32 m0, s59, 0
  s_nop 0
  buffer_load_dwordx4 v12, s[16:19], s79 offen lds
  ds_read_b64_tr_b16 v[28:29], v42 offset:7360
  ds_read_b64_tr_b16 v[30:31], v42 offset:8256
  s_waitcnt lgkmcnt(6)
  v_mfma_f32_32x32x16_bf16 v[64:79], v[32:35], a[72:75], v[64:79]
  ds_read_b64_tr_b16 v[32:33], v42 offset:10816
  ds_read_b64_tr_b16 v[34:35], v42 offset:11712
  s_waitcnt lgkmcnt(6)
  v_mfma_f32_32x32x16_bf16 v[80:95], v[20:23], a[72:75], v[80:95]
  s_add_u32 m0, s59, 1024
  s_nop 0
  buffer_load_dwordx4 v13, s[16:19], s79 offen lds
  ds_read_b64_tr_b16 v[20:21], v42 offset:10848
  ds_read_b64_tr_b16 v[22:23], v42 offset:11744
  s_waitcnt lgkmcnt(6)
  v_mfma_f32_32x32x16_bf16 v[96:111], v[24:27], a[72:75], v[96:111]
  ds_read_b64_tr_b16 v[24:25], v42 offset:10880
  ds_read_b64_tr_b16 v[26:27], v42 offset:11776
  s_waitcnt lgkmcnt(6)
  v_mfma_f32_32x32x16_bf16 v[112:127], v[28:31], a[72:75], v[112:127]
  s_add_u32 m0, s59, 2048
  s_nop 0
  buffer_load_dwordx4 v14, s[16:19], s79 offen lds
  ds_read_b64_tr_b16 v[28:29], v42 offset:10912
  ds_read_b64_tr_b16 v[30:31], v42 offset:11808
  s_waitcnt lgkmcnt(6)
  v_mfma_f32_32x32x16_bf16 v[48:63], v[32:35], a[76:79], v[48:63]
  ds_read_b64_tr_b16 v[32:33], v42 offset:10944
  ds_read_b64_tr_b16 v[34:35], v42 offset:11840
  s_waitcnt lgkmcnt(6)
  v_mfma_f32_32x32x16_bf16 v[64:79], v[20:23], a[76:79], v[64:79]
  s_add_u32 m0, s59, 3072
  s_nop 0
  buffer_load_dwordx4 v15, s[16:19], s79 offen lds
  v_add_u32 v42, 122880, v41
  ds_read_b64_tr_b16 v[20:21], v42 offset:64
  ds_read_b64_tr_b16 v[22:23], v42 offset:960
  s_waitcnt lgkmcnt(6)
  v_mfma_f32_32x32x16_bf16 v[80:95], v[24:27], a[76:79], v[80:95]
  ds_read_b64_tr_b16 v[24:25], v42 offset:96
  ds_read_b64_tr_b16 v[26:27], v42 offset:992
  s_waitcnt lgkmcnt(6)
  v_mfma_f32_32x32x16_bf16 v[96:111], v[28:31], a[76:79], v[96:111]
  ds_read_b64_tr_b16 v[28:29], v42 offset:128
  ds_read_b64_tr_b16 v[30:31], v42 offset:1024
  s_waitcnt lgkmcnt(6)
  v_mfma_f32_32x32x16_bf16 v[112:127], v[32:35], a[76:79], v[112:127]
  ds_read_b64_tr_b16 v[32:33], v42 offset:160
  ds_read_b64_tr_b16 v[34:35], v42 offset:1056
  s_waitcnt lgkmcnt(6)
  v_mfma_f32_32x32x16_bf16 v[48:63], v[20:23], a[80:83], v[48:63]
  ds_read_b64_tr_b16 v[20:21], v42 offset:192
  ds_read_b64_tr_b16 v[22:23], v42 offset:1088
  s_waitcnt lgkmcnt(6)
  v_mfma_f32_32x32x16_bf16 v[64:79], v[24:27], a[80:83], v[64:79]
  ds_read_b64_tr_b16 v[24:25], v42 offset:3648
  ds_read_b64_tr_b16 v[26:27], v42 offset:4544
  s_waitcnt lgkmcnt(6)
  v_mfma_f32_32x32x16_bf16 v[80:95], v[28:31], a[80:83], v[80:95]
  ds_read_b64_tr_b16 v[28:29], v42 offset:3680
  ds_read_b64_tr_b16 v[30:31], v42 offset:4576
  s_waitcnt lgkmcnt(6)
  v_mfma_f32_32x32x16_bf16 v[96:111], v[32:35], a[80:83], v[96:111]
  ds_read_b64_tr_b16 v[32:33], v42 offset:3712
  ds_read_b64_tr_b16 v[34:35], v42 offset:4608
  s_waitcnt lgkmcnt(6)
  v_mfma_f32_32x32x16_bf16 v[112:127], v[20:23], a[80:83], v[112:127]
  ds_read_b64_tr_b16 v[20:21], v42 offset:3744
  ds_read_b64_tr_b16 v[22:23], v42 offset:4640
  s_waitcnt lgkmcnt(6)
  v_mfma_f32_32x32x16_bf16 v[48:63], v[24:27], a[84:87], v[48:63]
  ds_read_b64_tr_b16 v[24:25], v42 offset:3776
  ds_read_b64_tr_b16 v[26:27], v42 offset:4672
  s_waitcnt lgkmcnt(6)
  v_mfma_f32_32x32x16_bf16 v[64:79], v[28:31], a[84:87], v[64:79]
  ds_read_b64_tr_b16 v[28:29], v42 offset:7232
  ds_read_b64_tr_b16 v[30:31], v42 offset:8128
  s_waitcnt lgkmcnt(6)
  v_mfma_f32_32x32x16_bf16 v[80:95], v[32:35], a[84:87], v[80:95]
  ds_read_b64_tr_b16 v[32:33], v42 offset:7264
  ds_read_b64_tr_b16 v[34:35], v42 offset:8160
  s_waitcnt lgkmcnt(6)
  v_mfma_f32_32x32x16_bf16 v[96:111], v[20:23], a[84:87], v[96:111]
  ds_read_b64_tr_b16 v[20:21], v42 offset:7296
  ds_read_b64_tr_b16 v[22:23], v42 offset:8192
  s_waitcnt lgkmcnt(6)
  v_mfma_f32_32x32x16_bf16 v[112:127], v[24:27], a[84:87], v[112:127]
  s_waitcnt vmcnt(4)
  s_barrier
  ds_read_b64_tr_b16 v[24:25], v42 offset:7328
  ds_read_b64_tr_b16 v[26:27], v42 offset:8224
  s_waitcnt lgkmcnt(6)
  v_mfma_f32_32x32x16_bf16 v[48:63], v[28:31], a[88:91], v[48:63]
  ds_read_b64_tr_b16 v[28:29], v42 offset:7360
  ds_read_b64_tr_b16 v[30:31], v42 offset:8256
  s_waitcnt lgkmcnt(6)
  v_mfma_f32_32x32x16_bf16 v[64:79], v[32:35], a[88:91], v[64:79]
  ds_read_b64_tr_b16 v[32:33], v42 offset:10816
  ds_read_b64_tr_b16 v[34:35], v42 offset:11712
  s_waitcnt lgkmcnt(6)
  v_mfma_f32_32x32x16_bf16 v[80:95], v[20:23], a[88:91], v[80:95]
  ds_read_b64_tr_b16 v[20:21], v42 offset:10848
  ds_read_b64_tr_b16 v[22:23], v42 offset:11744
  s_waitcnt lgkmcnt(6)
  v_mfma_f32_32x32x16_bf16 v[96:111], v[24:27], a[88:91], v[96:111]
  ds_read_b64_tr_b16 v[24:25], v42 offset:10880
  ds_read_b64_tr_b16 v[26:27], v42 offset:11776
  s_waitcnt lgkmcnt(6)
  v_mfma_f32_32x32x16_bf16 v[112:127], v[28:31], a[88:91], v[112:127]
  ds_read_b64_tr_b16 v[28:29], v42 offset:10912
  ds_read_b64_tr_b16 v[30:31], v42 offset:11808
  s_waitcnt lgkmcnt(6)
  v_mfma_f32_32x32x16_bf16 v[48:63], v[32:35], a[92:95], v[48:63]
  ds_read_b64_tr_b16 v[32:33], v42 offset:10944
  ds_read_b64_tr_b16 v[34:35], v42 offset:11840
  s_waitcnt lgkmcnt(6)
  v_mfma_f32_32x32x16_bf16 v[64:79], v[20:23], a[92:95], v[64:79]
  v_add_u32 v42, 86400, v41
  ds_read_b64_tr_b16 v[20:21], v42 offset:64
  ds_read_b64_tr_b16 v[22:23], v42 offset:960
  s_waitcnt lgkmcnt(6)
  v_mfma_f32_32x32x16_bf16 v[80:95], v[24:27], a[92:95], v[80:95]
  ds_read_b64_tr_b16 v[24:25], v42 offset:96
  ds_read_b64_tr_b16 v[26:27], v42 offset:992
  s_waitcnt lgkmcnt(6)
  v_mfma_f32_32x32x16_bf16 v[96:111], v[28:31], a[92:95], v[96:111]
  ds_read_b64_tr_b16 v[28:29], v42 offset:128
  ds_read_b64_tr_b16 v[30:31], v42 offset:1024
  s_waitcnt lgkmcnt(6)
  v_mfma_f32_32x32x16_bf16 v[112:127], v[32:35], a[92:95], v[112:127]
  ds_read_b64_tr_b16 v[32:33], v42 offset:160
  ds_read_b64_tr_b16 v[34:35], v42 offset:1056
  s_waitcnt lgkmcnt(6)
  v_mfma_f32_32x32x16_bf16 v[48:63], v[20:23], a[96:99], v[48:63]
  ds_read_b64_tr_b16 v[20:21], v42 offset:192
  ds_read_b64_tr_b16 v[22:23], v42 offset:1088
  s_waitcnt lgkmcnt(6)
  v_mfma_f32_32x32x16_bf16 v[64:79], v[24:27], a[96:99], v[64:79]
  ds_read_b64_tr_b16 v[24:25], v42 offset:3648
  ds_read_b64_tr_b16 v[26:27], v42 offset:4544
  s_waitcnt lgkmcnt(6)
  v_mfma_f32_32x32x16_bf16 v[80:95], v[28:31], a[96:99], v[80:95]
  ds_read_b64_tr_b16 v[28:29], v42 offset:3680
  ds_read_b64_tr_b16 v[30:31], v42 offset:4576
  s_waitcnt lgkmcnt(6)
  v_mfma_f32_32x32x16_bf16 v[96:111], v[32:35], a[96:99], v[96:111]
  ds_read_b64_tr_b16 v[32:33], v42 offset:3712
  ds_read_b64_tr_b16 v[34:35], v42 offset:4608
  s_waitcnt lgkmcnt(6)
  v_mfma_f32_32x32x16_bf16 v[112:127], v[20:23], a[96:99], v[112:127]
  ds_read_b64_tr_b16 v[20:21], v42 offset:3744
  ds_read_b64_tr_b16 v[22:23], v42 offset:4640
  s_waitcnt lgkmcnt(6)
  v_mfma_f32_32x32x16_bf16 v[48:63], v[24:27], a[100:103], v[48:63]
  ds_read_b64_tr_b16 v[24:25], v42 offset:3776
  ds_read_b64_tr_b16 v[26:27], v42 offset:4672
  s_waitcnt lgkmcnt(6)
  v_mfma_f32_32x32x16_bf16 v[64:79], v[28:31], a[100:103], v[64:79]
  ds_read_b64_tr_b16 v[28:29], v42 offset:7232
  ds_read_b64_tr_b16 v[30:31], v42 offset:8128
  s_waitcnt lgkmcnt(6)
  v_mfma_f32_32x32x16_bf16 v[80:95], v[32:35], a[100:103], v[80:95]
  ds_read_b64_tr_b16 v[32:33], v42 offset:7264
  ds_read_b64_tr_b16 v[34:35], v42 offset:8160
  s_waitcnt lgkmcnt(6)
  v_mfma_f32_32x32x16_bf16 v[96:111], v[20:23], a[100:103], v[96:111]
  ds_read_b64_tr_b16 v[20:21], v42 offset:7296
  ds_read_b64_tr_b16 v[22:23], v42 offset:8192
  s_waitcnt lgkmcnt(6)
  v_mfma_f32_32x32x16_bf16 v[112:127], v[24:27], a[100:103], v[112:127]
  s_waitcnt vmcnt(0)
  s_barrier
  v_lshlrev_b32 v19, 2, v1
  v_add_u32 v19, 159872, v19

  ds_read_b32 v36, v19 offset:256
  ds_read_b32 v37, v19 offset:384
  ds_read_b32 v38, v19 offset:512
  ds_read_b32 v39, v19 offset:640
  ds_read_b32 v40, v19 offset:768
  v_xor_b32 v4, 0x80000000, v44
  v_lshrrev_b32 v5, 16, v4
  v_and_b32 v4, 0xffff0000, v4
  v_or_b32 v4, v4, v5
  v_cmp_gt_u32 vcc, 32, v0
  s_nop 1
  v_cndmask_b32 v4, 0, v4, vcc
  v_cndmask_b32 v5, 0, v5, vcc
  v_mov_b32 v6, 0
  v_mov_b32 v7, 0

  v_mul_f32 v46, 0xbfb8aa3b, v45
  v_mul_f32 v47, v45, v45
  v_rcp_f32 v47, v47
  v_lshlrev_b32 v43, 4, v0
  s_mul_i32 s6, s47, 7168
  s_add_u32 s63, s61, s6

  ds_read_b64_tr_b16 v[24:25], v42 offset:7328
  ds_read_b64_tr_b16 v[26:27], v42 offset:8224
  s_waitcnt lgkmcnt(11)
  v_mfma_f32_32x32x16_bf16 v[48:63], v[28:31], a[104:107], v[48:63]
  ds_read_b64_tr_b16 v[28:29], v42 offset:7360
  ds_read_b64_tr_b16 v[30:31], v42 offset:8256
  s_waitcnt lgkmcnt(11)
  v_mfma_f32_32x32x16_bf16 v[64:79], v[32:35], a[104:107], v[64:79]
  ds_read_b64_tr_b16 v[32:33], v42 offset:10816
  ds_read_b64_tr_b16 v[34:35], v42 offset:11712
  s_waitcnt lgkmcnt(11)
  v_mfma_f32_32x32x16_bf16 v[80:95], v[20:23], a[104:107], v[80:95]
  ds_read_b64_tr_b16 v[20:21], v42 offset:10848
  ds_read_b64_tr_b16 v[22:23], v42 offset:11744
  s_waitcnt lgkmcnt(6)
  v_mfma_f32_32x32x16_bf16 v[96:111], v[24:27], a[104:107], v[96:111]
  ds_read_b64_tr_b16 v[24:25], v42 offset:10880
  ds_read_b64_tr_b16 v[26:27], v42 offset:11776
  s_waitcnt lgkmcnt(6)
  v_mfma_f32_32x32x16_bf16 v[112:127], v[28:31], a[104:107], v[112:127]
  ds_read_b64_tr_b16 v[28:29], v42 offset:10912
  ds_read_b64_tr_b16 v[30:31], v42 offset:11808
  s_waitcnt lgkmcnt(6)
  v_mfma_f32_32x32x16_bf16 v[48:63], v[32:35], a[108:111], v[48:63]
  ds_read_b64_tr_b16 v[32:33], v42 offset:10944
  ds_read_b64_tr_b16 v[34:35], v42 offset:11840
  s_waitcnt lgkmcnt(6)
  v_mfma_f32_32x32x16_bf16 v[64:79], v[20:23], a[108:111], v[64:79]
  v_add_u32 v42, 0, v41
  ds_read_b64_tr_b16 v[20:21], v42 offset:64
  ds_read_b64_tr_b16 v[22:23], v42 offset:960
  s_waitcnt lgkmcnt(6)
  v_mfma_f32_32x32x16_bf16 v[80:95], v[24:27], a[108:111], v[80:95]
  ds_read_b64_tr_b16 v[24:25], v42 offset:3648
  ds_read_b64_tr_b16 v[26:27], v42 offset:4544
  s_waitcnt lgkmcnt(6)
  v_mfma_f32_32x32x16_bf16 v[96:111], v[28:31], a[108:111], v[96:111]
  ds_read_b64_tr_b16 v[28:29], v42 offset:7232
  ds_read_b64_tr_b16 v[30:31], v42 offset:8128
  s_waitcnt lgkmcnt(6)
  v_mfma_f32_32x32x16_bf16 v[112:127], v[32:35], a[108:111], v[112:127]
  ds_read_b64_tr_b16 v[32:33], v42 offset:10816
  ds_read_b64_tr_b16 v[34:35], v42 offset:11712
  s_waitcnt lgkmcnt(6)
  v_mfma_f32_32x32x16_bf16 v[48:63], v[20:23], a[112:115], v[48:63]
  ds_read_b64_tr_b16 v[20:21], v42 offset:96
  ds_read_b64_tr_b16 v[22:23], v42 offset:992
  s_waitcnt lgkmcnt(6)
  v_mfma_f32_32x32x16_bf16 v[48:63], v[24:27], a[116:119], v[48:63]
  ds_read_b64_tr_b16 v[24:25], v42 offset:3680
  ds_read_b64_tr_b16 v[26:27], v42 offset:4576
  s_waitcnt lgkmcnt(6)
  v_mfma_f32_32x32x16_bf16 v[48:63], v[28:31], a[120:123], v[48:63]
  ds_read_b64_tr_b16 v[28:29], v42 offset:7264
  ds_read_b64_tr_b16 v[30:31], v42 offset:8160
  s_waitcnt lgkmcnt(6)
  v_mfma_f32_32x32x16_bf16 v[48:63], v[32:35], a[124:127], v[48:63]
  v_cvt_pk_bf16_f32 v12, v36, v36
  v_and_b32 v13, 0xffff0000, v12
  v_sub_f32 v36, v36, v13
  v_cvt_pk_bf16_f32 v14, v36, v36
  v_and_b32 v14, 0xffff0000, v14
  v_sub_f32 v36, v36, v14
  v_lshrrev_b32 v13, 16, v13
  v_or_b32 v8, v13, v14
  v_cvt_pk_bf16_f32 v9, v36, v36
  v_and_b32 v9, 0xffff, v9
  v_mov_b32 v10, 0
  v_mov_b32 v11, 0
  s_nop 1

  v_mfma_f32_32x32x16_bf16 v[48:63], v[8:11], v[4:7], v[48:63]
  ds_read_b64_tr_b16 v[32:33], v42 offset:10848
  ds_read_b64_tr_b16 v[34:35], v42 offset:11744
  s_waitcnt lgkmcnt(6)
  v_mfma_f32_32x32x16_bf16 v[64:79], v[20:23], a[112:115], v[64:79]
  ds_read_b64_tr_b16 v[20:21], v42 offset:128
  ds_read_b64_tr_b16 v[22:23], v42 offset:1024
  s_waitcnt lgkmcnt(6)
  v_mfma_f32_32x32x16_bf16 v[64:79], v[24:27], a[116:119], v[64:79]
  s_nop 4
  v_mul_f32 v12, v48, v46
  v_mul_f32 v14, v49, v46
  v_exp_f32 v12, v12
  v_exp_f32 v14, v14
  v_mul_f32 v13, v48, v56
  v_mul_f32 v15, v49, v57
  v_fma_f32 v12, v12, v47, v47
  v_fma_f32 v14, v14, v47, v47
  v_rcp_f32 v12, v12
  v_rcp_f32 v14, v14
  s_nop 0
  v_mul_f32 v13, v13, v12
  v_mul_f32 v15, v15, v14
  v_cvt_pk_bf16_f32 v16, v13, v15

  ds_read_b64_tr_b16 v[24:25], v42 offset:3712
  ds_read_b64_tr_b16 v[26:27], v42 offset:4608
  s_waitcnt lgkmcnt(6)
  v_mfma_f32_32x32x16_bf16 v[64:79], v[28:31], a[120:123], v[64:79]
  v_mul_f32 v12, v50, v46
  v_mul_f32 v14, v51, v46
  v_exp_f32 v12, v12
  v_exp_f32 v14, v14
  v_mul_f32 v13, v50, v58
  v_mul_f32 v15, v51, v59
  v_fma_f32 v12, v12, v47, v47
  v_fma_f32 v14, v14, v47, v47
  v_rcp_f32 v12, v12
  v_rcp_f32 v14, v14
  s_nop 0
  v_mul_f32 v13, v13, v12
  v_mul_f32 v15, v15, v14
  v_cvt_pk_bf16_f32 v17, v13, v15

  ds_read_b64_tr_b16 v[28:29], v42 offset:7296
  ds_read_b64_tr_b16 v[30:31], v42 offset:8192
  s_waitcnt lgkmcnt(6)
  v_mfma_f32_32x32x16_bf16 v[64:79], v[32:35], a[124:127], v[64:79]
  v_mul_f32 v12, v52, v46
  v_mul_f32 v14, v53, v46
  v_exp_f32 v12, v12
  v_exp_f32 v14, v14
  v_mul_f32 v13, v52, v60
  v_mul_f32 v15, v53, v61
  v_fma_f32 v12, v12, v47, v47
  v_fma_f32 v14, v14, v47, v47
  v_rcp_f32 v12, v12
  v_rcp_f32 v14, v14
  s_nop 0
  v_mul_f32 v13, v13, v12
  v_mul_f32 v15, v15, v14
  v_cvt_pk_bf16_f32 v18, v13, v15

  v_mul_f32 v12, v54, v46
  v_mul_f32 v14, v55, v46
  v_exp_f32 v12, v12
  v_exp_f32 v14, v14
  v_mul_f32 v13, v54, v62
  v_mul_f32 v15, v55, v63
  v_fma_f32 v12, v12, v47, v47
  v_fma_f32 v14, v14, v47, v47
  v_rcp_f32 v12, v12
  v_rcp_f32 v14, v14
  s_nop 0
  v_mul_f32 v13, v13, v12
  v_mul_f32 v15, v15, v14
  v_cvt_pk_bf16_f32 v19, v13, v15

  s_add_u32 s6, s63, 2048
  buffer_store_dwordx4 v[16:19], v43, s[20:23], s6 offen sc1
  s_nop 1
  v_cvt_pk_bf16_f32 v12, v37, v37
  v_and_b32 v13, 0xffff0000, v12
  v_sub_f32 v37, v37, v13
  v_cvt_pk_bf16_f32 v14, v37, v37
  v_and_b32 v14, 0xffff0000, v14
  v_sub_f32 v37, v37, v14
  v_lshrrev_b32 v13, 16, v13
  v_or_b32 v8, v13, v14
  v_cvt_pk_bf16_f32 v9, v37, v37
  v_and_b32 v9, 0xffff, v9
  v_mov_b32 v10, 0
  v_mov_b32 v11, 0
  s_nop 1

  v_mfma_f32_32x32x16_bf16 v[64:79], v[8:11], v[4:7], v[64:79]
  ds_read_b64_tr_b16 v[32:33], v42 offset:10880
  ds_read_b64_tr_b16 v[34:35], v42 offset:11776
  s_waitcnt lgkmcnt(6)
  v_mfma_f32_32x32x16_bf16 v[80:95], v[20:23], a[112:115], v[80:95]
  ds_read_b64_tr_b16 v[20:21], v42 offset:160
  ds_read_b64_tr_b16 v[22:23], v42 offset:1056
  s_waitcnt lgkmcnt(6)
  v_mfma_f32_32x32x16_bf16 v[80:95], v[24:27], a[116:119], v[80:95]
  s_nop 4
  v_mul_f32 v12, v64, v46
  v_mul_f32 v14, v65, v46
  v_exp_f32 v12, v12
  v_exp_f32 v14, v14
  v_mul_f32 v13, v64, v72
  v_mul_f32 v15, v65, v73
  v_fma_f32 v12, v12, v47, v47
  v_fma_f32 v14, v14, v47, v47
  v_rcp_f32 v12, v12
  v_rcp_f32 v14, v14
  s_nop 0
  v_mul_f32 v13, v13, v12
  v_mul_f32 v15, v15, v14
  v_cvt_pk_bf16_f32 v16, v13, v15

  ds_read_b64_tr_b16 v[24:25], v42 offset:3744
  ds_read_b64_tr_b16 v[26:27], v42 offset:4640
  s_waitcnt lgkmcnt(6)
  v_mfma_f32_32x32x16_bf16 v[80:95], v[28:31], a[120:123], v[80:95]
  v_mul_f32 v12, v66, v46
  v_mul_f32 v14, v67, v46
  v_exp_f32 v12, v12
  v_exp_f32 v14, v14
  v_mul_f32 v13, v66, v74
  v_mul_f32 v15, v67, v75
  v_fma_f32 v12, v12, v47, v47
  v_fma_f32 v14, v14, v47, v47
  v_rcp_f32 v12, v12
  v_rcp_f32 v14, v14
  s_nop 0
  v_mul_f32 v13, v13, v12
  v_mul_f32 v15, v15, v14
  v_cvt_pk_bf16_f32 v17, v13, v15

  ds_read_b64_tr_b16 v[28:29], v42 offset:7328
  ds_read_b64_tr_b16 v[30:31], v42 offset:8224
  s_waitcnt lgkmcnt(6)
  v_mfma_f32_32x32x16_bf16 v[80:95], v[32:35], a[124:127], v[80:95]
  v_mul_f32 v12, v68, v46
  v_mul_f32 v14, v69, v46
  v_exp_f32 v12, v12
  v_exp_f32 v14, v14
  v_mul_f32 v13, v68, v76
  v_mul_f32 v15, v69, v77
  v_fma_f32 v12, v12, v47, v47
  v_fma_f32 v14, v14, v47, v47
  v_rcp_f32 v12, v12
  v_rcp_f32 v14, v14
  s_nop 0
  v_mul_f32 v13, v13, v12
  v_mul_f32 v15, v15, v14
  v_cvt_pk_bf16_f32 v18, v13, v15

  v_mul_f32 v12, v70, v46
  v_mul_f32 v14, v71, v46
  v_exp_f32 v12, v12
  v_exp_f32 v14, v14
  v_mul_f32 v13, v70, v78
  v_mul_f32 v15, v71, v79
  v_fma_f32 v12, v12, v47, v47
  v_fma_f32 v14, v14, v47, v47
  v_rcp_f32 v12, v12
  v_rcp_f32 v14, v14
  s_nop 0
  v_mul_f32 v13, v13, v12
  v_mul_f32 v15, v15, v14
  v_cvt_pk_bf16_f32 v19, v13, v15

  s_add_u32 s6, s63, 3072
  buffer_store_dwordx4 v[16:19], v43, s[20:23], s6 offen sc1
  s_nop 1
  v_cvt_pk_bf16_f32 v12, v38, v38
  v_and_b32 v13, 0xffff0000, v12
  v_sub_f32 v38, v38, v13
  v_cvt_pk_bf16_f32 v14, v38, v38
  v_and_b32 v14, 0xffff0000, v14
  v_sub_f32 v38, v38, v14
  v_lshrrev_b32 v13, 16, v13
  v_or_b32 v8, v13, v14
  v_cvt_pk_bf16_f32 v9, v38, v38
  v_and_b32 v9, 0xffff, v9
  v_mov_b32 v10, 0
  v_mov_b32 v11, 0
  s_nop 1

  v_mfma_f32_32x32x16_bf16 v[80:95], v[8:11], v[4:7], v[80:95]
  ds_read_b64_tr_b16 v[32:33], v42 offset:10912
  ds_read_b64_tr_b16 v[34:35], v42 offset:11808
  s_waitcnt lgkmcnt(6)
  v_mfma_f32_32x32x16_bf16 v[96:111], v[20:23], a[112:115], v[96:111]
  ds_read_b64_tr_b16 v[20:21], v42 offset:192
  ds_read_b64_tr_b16 v[22:23], v42 offset:1088
  s_waitcnt lgkmcnt(6)
  v_mfma_f32_32x32x16_bf16 v[96:111], v[24:27], a[116:119], v[96:111]
  s_nop 4
  v_mul_f32 v12, v80, v46
  v_mul_f32 v14, v81, v46
  v_exp_f32 v12, v12
  v_exp_f32 v14, v14
  v_mul_f32 v13, v80, v88
  v_mul_f32 v15, v81, v89
  v_fma_f32 v12, v12, v47, v47
  v_fma_f32 v14, v14, v47, v47
  v_rcp_f32 v12, v12
  v_rcp_f32 v14, v14
  s_nop 0
  v_mul_f32 v13, v13, v12
  v_mul_f32 v15, v15, v14
  v_cvt_pk_bf16_f32 v16, v13, v15

  ds_read_b64_tr_b16 v[24:25], v42 offset:3776
  ds_read_b64_tr_b16 v[26:27], v42 offset:4672
  s_waitcnt lgkmcnt(6)
  v_mfma_f32_32x32x16_bf16 v[96:111], v[28:31], a[120:123], v[96:111]
  v_mul_f32 v12, v82, v46
  v_mul_f32 v14, v83, v46
  v_exp_f32 v12, v12
  v_exp_f32 v14, v14
  v_mul_f32 v13, v82, v90
  v_mul_f32 v15, v83, v91
  v_fma_f32 v12, v12, v47, v47
  v_fma_f32 v14, v14, v47, v47
  v_rcp_f32 v12, v12
  v_rcp_f32 v14, v14
  s_nop 0
  v_mul_f32 v13, v13, v12
  v_mul_f32 v15, v15, v14
  v_cvt_pk_bf16_f32 v17, v13, v15

  ds_read_b64_tr_b16 v[28:29], v42 offset:7360
  ds_read_b64_tr_b16 v[30:31], v42 offset:8256
  s_waitcnt lgkmcnt(6)
  v_mfma_f32_32x32x16_bf16 v[96:111], v[32:35], a[124:127], v[96:111]
  v_mul_f32 v12, v84, v46
  v_mul_f32 v14, v85, v46
  v_exp_f32 v12, v12
  v_exp_f32 v14, v14
  v_mul_f32 v13, v84, v92
  v_mul_f32 v15, v85, v93
  v_fma_f32 v12, v12, v47, v47
  v_fma_f32 v14, v14, v47, v47
  v_rcp_f32 v12, v12
  v_rcp_f32 v14, v14
  s_nop 0
  v_mul_f32 v13, v13, v12
  v_mul_f32 v15, v15, v14
  v_cvt_pk_bf16_f32 v18, v13, v15

  v_mul_f32 v12, v86, v46
  v_mul_f32 v14, v87, v46
  v_exp_f32 v12, v12
  v_exp_f32 v14, v14
  v_mul_f32 v13, v86, v94
  v_mul_f32 v15, v87, v95
  v_fma_f32 v12, v12, v47, v47
  v_fma_f32 v14, v14, v47, v47
  v_rcp_f32 v12, v12
  v_rcp_f32 v14, v14
  s_nop 0
  v_mul_f32 v13, v13, v12
  v_mul_f32 v15, v15, v14
  v_cvt_pk_bf16_f32 v19, v13, v15

  s_add_u32 s6, s63, 4096
  buffer_store_dwordx4 v[16:19], v43, s[20:23], s6 offen sc1
  s_nop 1
  v_cvt_pk_bf16_f32 v12, v39, v39
  v_and_b32 v13, 0xffff0000, v12
  v_sub_f32 v39, v39, v13
  v_cvt_pk_bf16_f32 v14, v39, v39
  v_and_b32 v14, 0xffff0000, v14
  v_sub_f32 v39, v39, v14
  v_lshrrev_b32 v13, 16, v13
  v_or_b32 v8, v13, v14
  v_cvt_pk_bf16_f32 v9, v39, v39
  v_and_b32 v9, 0xffff, v9
  v_mov_b32 v10, 0
  v_mov_b32 v11, 0
  s_nop 1

  v_mfma_f32_32x32x16_bf16 v[96:111], v[8:11], v[4:7], v[96:111]
  ds_read_b64_tr_b16 v[32:33], v42 offset:10944
  ds_read_b64_tr_b16 v[34:35], v42 offset:11840
  s_waitcnt lgkmcnt(6)
  v_mfma_f32_32x32x16_bf16 v[112:127], v[20:23], a[112:115], v[112:127]
  s_waitcnt lgkmcnt(4)
  v_mfma_f32_32x32x16_bf16 v[112:127], v[24:27], a[116:119], v[112:127]
  s_nop 4
  v_mul_f32 v12, v96, v46
  v_mul_f32 v14, v97, v46
  v_exp_f32 v12, v12
  v_exp_f32 v14, v14
  v_mul_f32 v13, v96, v104
  v_mul_f32 v15, v97, v105
  v_fma_f32 v12, v12, v47, v47
  v_fma_f32 v14, v14, v47, v47
  v_rcp_f32 v12, v12
  v_rcp_f32 v14, v14
  s_nop 0
  v_mul_f32 v13, v13, v12
  v_mul_f32 v15, v15, v14
  v_cvt_pk_bf16_f32 v16, v13, v15

  s_waitcnt lgkmcnt(2)
  v_mfma_f32_32x32x16_bf16 v[112:127], v[28:31], a[120:123], v[112:127]
  v_mul_f32 v12, v98, v46
  v_mul_f32 v14, v99, v46
  v_exp_f32 v12, v12
  v_exp_f32 v14, v14
  v_mul_f32 v13, v98, v106
  v_mul_f32 v15, v99, v107
  v_fma_f32 v12, v12, v47, v47
  v_fma_f32 v14, v14, v47, v47
  v_rcp_f32 v12, v12
  v_rcp_f32 v14, v14
  s_nop 0
  v_mul_f32 v13, v13, v12
  v_mul_f32 v15, v15, v14
  v_cvt_pk_bf16_f32 v17, v13, v15

  s_waitcnt lgkmcnt(0)
  v_mfma_f32_32x32x16_bf16 v[112:127], v[32:35], a[124:127], v[112:127]
  v_mul_f32 v12, v100, v46
  v_mul_f32 v14, v101, v46
  v_exp_f32 v12, v12
  v_exp_f32 v14, v14
  v_mul_f32 v13, v100, v108
  v_mul_f32 v15, v101, v109
  v_fma_f32 v12, v12, v47, v47
  v_fma_f32 v14, v14, v47, v47
  v_rcp_f32 v12, v12
  v_rcp_f32 v14, v14
  s_nop 0
  v_mul_f32 v13, v13, v12
  v_mul_f32 v15, v15, v14
  v_cvt_pk_bf16_f32 v18, v13, v15

  v_mul_f32 v12, v102, v46
  v_mul_f32 v14, v103, v46
  v_exp_f32 v12, v12
  v_exp_f32 v14, v14
  v_mul_f32 v13, v102, v110
  v_mul_f32 v15, v103, v111
  v_fma_f32 v12, v12, v47, v47
  v_fma_f32 v14, v14, v47, v47
  v_rcp_f32 v12, v12
  v_rcp_f32 v14, v14
  s_nop 0
  v_mul_f32 v13, v13, v12
  v_mul_f32 v15, v15, v14
  v_cvt_pk_bf16_f32 v19, v13, v15

  s_add_u32 s6, s63, 5120
  buffer_store_dwordx4 v[16:19], v43, s[20:23], s6 offen sc1
  s_nop 1
  v_cvt_pk_bf16_f32 v12, v40, v40
  v_and_b32 v13, 0xffff0000, v12
  v_sub_f32 v40, v40, v13
  v_cvt_pk_bf16_f32 v14, v40, v40
  v_and_b32 v14, 0xffff0000, v14
  v_sub_f32 v40, v40, v14
  v_lshrrev_b32 v13, 16, v13
  v_or_b32 v8, v13, v14
  v_cvt_pk_bf16_f32 v9, v40, v40
  v_and_b32 v9, 0xffff, v9
  v_mov_b32 v10, 0
  v_mov_b32 v11, 0
  s_nop 1

  v_mfma_f32_32x32x16_bf16 v[112:127], v[8:11], v[4:7], v[112:127]
  s_nop 11
  s_nop 4
  v_mul_f32 v12, v112, v46
  v_mul_f32 v14, v113, v46
  v_exp_f32 v12, v12
  v_exp_f32 v14, v14
  v_mul_f32 v13, v112, v120
  v_mul_f32 v15, v113, v121
  v_fma_f32 v12, v12, v47, v47
  v_fma_f32 v14, v14, v47, v47
  v_rcp_f32 v12, v12
  v_rcp_f32 v14, v14
  s_nop 0
  v_mul_f32 v13, v13, v12
  v_mul_f32 v15, v15, v14
  v_cvt_pk_bf16_f32 v16, v13, v15

  v_mul_f32 v12, v114, v46
  v_mul_f32 v14, v115, v46
  v_exp_f32 v12, v12
  v_exp_f32 v14, v14
  v_mul_f32 v13, v114, v122
  v_mul_f32 v15, v115, v123
  v_fma_f32 v12, v12, v47, v47
  v_fma_f32 v14, v14, v47, v47
  v_rcp_f32 v12, v12
  v_rcp_f32 v14, v14
  s_nop 0
  v_mul_f32 v13, v13, v12
  v_mul_f32 v15, v15, v14
  v_cvt_pk_bf16_f32 v17, v13, v15

  v_mul_f32 v12, v116, v46
  v_mul_f32 v14, v117, v46
  v_exp_f32 v12, v12
  v_exp_f32 v14, v14
  v_mul_f32 v13, v116, v124
  v_mul_f32 v15, v117, v125
  v_fma_f32 v12, v12, v47, v47
  v_fma_f32 v14, v14, v47, v47
  v_rcp_f32 v12, v12
  v_rcp_f32 v14, v14
  s_nop 0
  v_mul_f32 v13, v13, v12
  v_mul_f32 v15, v15, v14
  v_cvt_pk_bf16_f32 v18, v13, v15

  v_mul_f32 v12, v118, v46
  v_mul_f32 v14, v119, v46
  v_exp_f32 v12, v12
  v_exp_f32 v14, v14
  v_mul_f32 v13, v118, v126
  v_mul_f32 v15, v119, v127
  v_fma_f32 v12, v12, v47, v47
  v_fma_f32 v14, v14, v47, v47
  v_rcp_f32 v12, v12
  v_rcp_f32 v14, v14
  s_nop 0
  v_mul_f32 v13, v13, v12
  v_mul_f32 v15, v15, v14
  v_cvt_pk_bf16_f32 v19, v13, v15

  s_add_u32 s6, s63, 6144
  buffer_store_dwordx4 v[16:19], v43, s[20:23], s6 offen sc1
  s_nop 1
  s_branch LB_dphase
LB_dphase:
  s_setprio 0
  s_load_dwordx2 s[28:29], s[0:1], 104
  s_load_dwordx2 s[30:31], s[0:1], 64
  s_load_dwordx2 s[6:7], s[0:1], 112
  v_and_b32 v0, 63, v0
  s_and_b32 s3, s2, 7
  s_lshr_b32 s27, s2, 3
  s_lshr_b32 s24, s3, 1
  s_lshl_b32 s24, s24, 3
  s_and_b32 s25, s27, 7
  s_add_u32 s24, s24, s25
  s_and_b32 s25, s3, 1
  s_lshl_b32 s25, s25, 2
  s_lshr_b32 s27, s27, 3
  s_add_u32 s25, s25, s27

  s_waitcnt lgkmcnt(0)
  s_mov_b32 s16, s28
  s_and_b32 s17, s29, 0xffff
  s_mov_b32 s18, 4194304
  s_mov_b32 s19, 0x20000
  s_mov_b32 s12, s30
  s_and_b32 s13, s31, 0xffff
  s_mov_b32 s14, 1024
  s_mov_b32 s15, 0x20000
  s_mul_i32 s32, s44, 22528
  s_mul_i32 s33, s24, 360448
  s_add_u32 s33, s33, s32
  s_mul_i32 s34, s25, 360448
  s_add_u32 s34, s34, s32
  s_add_u32 s34, s34, 11534336
  v_lshlrev_b32 v2, 4, v0
  v_add_u32 v3, s33, v2
  v_add_u32 v4, 180224, v3
  v_add_u32 v5, s34, v2
  v_add_u32 v6, 180224, v5

  s_mov_b32 s48, 0
  s_mov_b32 s49, 4096
  s_mov_b32 s50, 8192
  s_mov_b32 s51, 12288
  s_mov_b32 s52, 16384
  s_mov_b32 s53, 20480
  s_lshr_b32 s35, s44, 2
  s_lshr_b32 s36, s44, 1
  s_and_b32 s36, s36, 1
  s_and_b32 s39, s44, 1
  s_lshl_b32 s37, s24, 6
  s_lshl_b32 s35, s35, 5
  s_add_u32 s37, s37, s35
  s_lshl_b32 s35, s39, 3
  s_add_u32 s37, s37, s35
  s_lshl_b32 s38, s25, 6
  s_lshl_b32 s36, s36, 5
  s_add_u32 s38, s38, s36
  v_lshrrev_b32 v7, 5, v0
  v_lshlrev_b32 v7, 4, v7
  v_add_u32 v7, s37, v7
  v_and_b32 v8, 31, v0
  v_add_u32 v8, s38, v8
  v_lshlrev_b32 v9, 10, v7
  v_lshl_add_u32 v9, v8, 1, v9
  v_lshlrev_b32 v10, 1, v9
  v_lshlrev_b32 v11, 3, v7
  v_add_u32 v11, 14417920, v11
  v_lshlrev_b32 v12, 1, v8

  v_accvgpr_write_b32 a0, 0
  v_accvgpr_write_b32 a1, 0
  v_accvgpr_write_b32 a2, 0
  v_accvgpr_write_b32 a3, 0
  v_accvgpr_write_b32 a4, 0
  v_accvgpr_write_b32 a5, 0
  v_accvgpr_write_b32 a6, 0
  v_accvgpr_write_b32 a7, 0
  v_accvgpr_write_b32 a8, 0
  v_accvgpr_write_b32 a9, 0
  v_accvgpr_write_b32 a10, 0
  v_accvgpr_write_b32 a11, 0
  v_accvgpr_write_b32 a12, 0
  v_accvgpr_write_b32 a13, 0
  v_accvgpr_write_b32 a14, 0
  v_accvgpr_write_b32 a15, 0
  v_accvgpr_write_b32 a16, 0
  v_accvgpr_write_b32 a17, 0
  v_accvgpr_write_b32 a18, 0
  v_accvgpr_write_b32 a19, 0
  v_accvgpr_write_b32 a20, 0
  v_accvgpr_write_b32 a21, 0
  v_accvgpr_write_b32 a22, 0
  v_accvgpr_write_b32 a23, 0
  v_accvgpr_write_b32 a24, 0
  v_accvgpr_write_b32 a25, 0
  v_accvgpr_write_b32 a26, 0
  v_accvgpr_write_b32 a27, 0
  v_accvgpr_write_b32 a28, 0
  v_accvgpr_write_b32 a29, 0
  v_accvgpr_write_b32 a30, 0
  v_accvgpr_write_b32 a31, 0
  v_accvgpr_write_b32 a32, 0
  v_accvgpr_write_b32 a33, 0
  v_accvgpr_write_b32 a34, 0
  v_accvgpr_write_b32 a35, 0
  v_accvgpr_write_b32 a36, 0
  v_accvgpr_write_b32 a37, 0
  v_accvgpr_write_b32 a38, 0
  v_accvgpr_write_b32 a39, 0
  v_accvgpr_write_b32 a40, 0
  v_accvgpr_write_b32 a41, 0
  v_accvgpr_write_b32 a42, 0
  v_accvgpr_write_b32 a43, 0
  v_accvgpr_write_b32 a44, 0
  v_accvgpr_write_b32 a45, 0
  v_accvgpr_write_b32 a46, 0
  v_accvgpr_write_b32 a47, 0
  v_accvgpr_write_b32 a48, 0
  v_accvgpr_write_b32 a49, 0
  v_accvgpr_write_b32 a50, 0
  v_accvgpr_write_b32 a51, 0
  v_accvgpr_write_b32 a52, 0
  v_accvgpr_write_b32 a53, 0
  v_accvgpr_write_b32 a54, 0
  v_accvgpr_write_b32 a55, 0
  v_accvgpr_write_b32 a56, 0
  v_accvgpr_write_b32 a57, 0
  v_accvgpr_write_b32 a58, 0
  v_accvgpr_write_b32 a59, 0
  v_accvgpr_write_b32 a60, 0
  v_accvgpr_write_b32 a61, 0
  v_accvgpr_write_b32 a62, 0
  v_accvgpr_write_b32 a63, 0
  v_mov_b32 v13, 160896
  ds_read_b64 v[20:21], v13
  ds_read_b32 v22, v13 offset:16
  s_waitcnt lgkmcnt(0)
  v_readfirstlane_b32 s96, v20
  v_readfirstlane_b32 s97, v21
  v_readfirstlane_b32 s98, v22
  s_cmp_eq_u32 s98, 1
  s_cbranch_scc1 LF_rpf_ok
  s_lshl_b32 s3, s25, 1
  v_bfe_u32 v13, v0, 4, 1
  v_add_u32 v13, s3, v13
  v_lshlrev_b32 v13, 7, v13
  v_and_b32 v14, 15, v0
  v_lshl_add_u32 v13, v14, 3, v13
  s_mov_b32 s3, 14829568
  s_mov_b32 s4, 0

LF_rpf_poll:
  buffer_load_dwordx2 v[16:17], v13, s[20:23], s3 offen sc1
  s_waitcnt vmcnt(0)
  v_xor_b32 v16, s96, v16
  v_xor_b32 v17, s97, v17
  v_or_b32 v16, v16, v17
  v_cmp_ne_u32 vcc, 0, v16
  s_nop 1
  s_cmp_eq_u64 vcc, 0
  s_cbranch_scc1 LF_rpf_ok
  s_add_u32 s4, s4, 1
  s_cmp_gt_u32 s4, 0x10000
  s_cbranch_scc1 LF_rpf_ok
  s_sleep 4
  s_branch LF_rpf_poll

LF_rpf_ok:
  buffer_load_dwordx4 a[96:99], v5, s[20:23], s50 offen offset:1024 sc1
  buffer_load_dwordx4 a[100:103], v6, s[20:23], s50 offen offset:1024 sc1
  buffer_load_dwordx4 a[104:107], v5, s[20:23], s50 offen offset:2048 sc1
  buffer_load_dwordx4 a[108:111], v6, s[20:23], s50 offen offset:2048 sc1
  buffer_load_dwordx4 a[112:115], v5, s[20:23], s50 offen offset:3072 sc1
  buffer_load_dwordx4 a[116:119], v6, s[20:23], s50 offen offset:3072 sc1
  buffer_load_dwordx4 a[120:123], v5, s[20:23], s51 offen offset:0 sc1
  buffer_load_dwordx4 a[124:127], v6, s[20:23], s51 offen offset:0 sc1
  buffer_load_dwordx4 v[72:75], v5, s[20:23], s51 offen offset:1024 sc1
  buffer_load_dwordx4 v[76:79], v6, s[20:23], s51 offen offset:1024 sc1
  buffer_load_dwordx4 v[80:83], v5, s[20:23], s51 offen offset:2048 sc1
  buffer_load_dwordx4 v[84:87], v6, s[20:23], s51 offen offset:2048 sc1
  buffer_load_dwordx4 v[88:91], v5, s[20:23], s51 offen offset:3072 sc1
  buffer_load_dwordx4 v[92:95], v6, s[20:23], s51 offen offset:3072 sc1
  buffer_load_dwordx4 v[96:99], v5, s[20:23], s52 offen offset:0 sc1
  buffer_load_dwordx4 v[100:103], v6, s[20:23], s52 offen offset:0 sc1
  buffer_load_dwordx4 v[104:107], v5, s[20:23], s52 offen offset:1024 sc1
  buffer_load_dwordx4 v[108:111], v6, s[20:23], s52 offen offset:1024 sc1
  s_waitcnt vmcnt(18) lgkmcnt(0)
  s_barrier
  s_cmp_lg_u32 s44, 0
  s_cbranch_scc1 LF_nosig
  s_lshl_b32 s5, s46, 7
  s_lshl_b32 s3, s47, 3
  s_add_u32 s5, s5, s3
  s_add_u32 s5, s5, 14827520
  v_mov_b32 v22, 0
  v_mov_b32 v20, s96
  v_mov_b32 v21, s97
  s_mov_b64 exec, 1
  buffer_store_dwordx2 v[20:21], v22, s[20:23], s5 offen sc1
  s_mov_b64 exec, -1

LF_nosig:
  buffer_load_ushort a64, v9, s[8:11], s48 offen offset:0
  buffer_load_ushort a65, v9, s[8:11], s48 offen offset:1024
  buffer_load_ushort a66, v9, s[8:11], s48 offen offset:2048
  buffer_load_ushort a67, v9, s[8:11], s48 offen offset:3072
  buffer_load_ushort a68, v9, s[8:11], s49 offen offset:0
  buffer_load_ushort a69, v9, s[8:11], s49 offen offset:1024
  buffer_load_ushort a70, v9, s[8:11], s49 offen offset:2048
  buffer_load_ushort a71, v9, s[8:11], s49 offen offset:3072
  buffer_load_ushort a72, v12, s[12:15], 0 offen
  s_mul_i32 s40, s44, 18432
  s_add_u32 m0, s40, 0
  s_nop 0
  s_mov_b32 s41, 0
  buffer_load_dwordx4 v5, s[20:23], s41 offen sc1 lds
  s_add_u32 m0, s40, 1024
  s_nop 0
  s_mov_b32 s41, 0
  buffer_load_dwordx4 v6, s[20:23], s41 offen sc1 lds
  s_add_u32 m0, s40, 2048
  s_nop 0
  s_mov_b32 s41, 1024
  buffer_load_dwordx4 v5, s[20:23], s41 offen sc1 lds
  s_add_u32 m0, s40, 3072
  s_nop 0
  s_mov_b32 s41, 1024
  buffer_load_dwordx4 v6, s[20:23], s41 offen sc1 lds
  s_add_u32 m0, s40, 4096
  s_nop 0
  s_mov_b32 s41, 2048
  buffer_load_dwordx4 v5, s[20:23], s41 offen sc1 lds
  s_add_u32 m0, s40, 5120
  s_nop 0
  s_mov_b32 s41, 2048
  buffer_load_dwordx4 v6, s[20:23], s41 offen sc1 lds
  s_add_u32 m0, s40, 6144
  s_nop 0
  s_mov_b32 s41, 3072
  buffer_load_dwordx4 v5, s[20:23], s41 offen sc1 lds
  s_add_u32 m0, s40, 7168
  s_nop 0
  s_mov_b32 s41, 3072
  buffer_load_dwordx4 v6, s[20:23], s41 offen sc1 lds
  s_add_u32 m0, s40, 8192
  s_nop 0
  s_mov_b32 s41, 4096
  buffer_load_dwordx4 v5, s[20:23], s41 offen sc1 lds
  s_add_u32 m0, s40, 9216
  s_nop 0
  s_mov_b32 s41, 4096
  buffer_load_dwordx4 v6, s[20:23], s41 offen sc1 lds
  s_add_u32 m0, s40, 10240
  s_nop 0
  s_mov_b32 s41, 5120
  buffer_load_dwordx4 v5, s[20:23], s41 offen sc1 lds
  s_add_u32 m0, s40, 11264
  s_nop 0
  s_mov_b32 s41, 5120
  buffer_load_dwordx4 v6, s[20:23], s41 offen sc1 lds
  s_add_u32 m0, s40, 12288
  s_nop 0
  s_mov_b32 s41, 6144
  buffer_load_dwordx4 v5, s[20:23], s41 offen sc1 lds
  s_add_u32 m0, s40, 13312
  s_nop 0
  s_mov_b32 s41, 6144
  buffer_load_dwordx4 v6, s[20:23], s41 offen sc1 lds
  s_add_u32 m0, s40, 14336
  s_nop 0
  s_mov_b32 s41, 7168
  buffer_load_dwordx4 v5, s[20:23], s41 offen sc1 lds
  s_add_u32 m0, s40, 15360
  s_nop 0
  s_mov_b32 s41, 7168
  buffer_load_dwordx4 v6, s[20:23], s41 offen sc1 lds
  s_add_u32 m0, s40, 16384
  s_nop 0
  s_mov_b32 s41, 8192
  buffer_load_dwordx4 v5, s[20:23], s41 offen sc1 lds
  s_add_u32 m0, s40, 17408
  s_nop 0
  s_mov_b32 s41, 8192
  buffer_load_dwordx4 v6, s[20:23], s41 offen sc1 lds
  v_lshlrev_b32 v18, 4, v0
  v_add_u32 v18, s40, v18

  s_cmp_lg_u32 s44, 0
  s_cbranch_scc1 LF_nopollA

  s_lshr_b32 s3, s24, 1
  v_mov_b32 v13, s3

  v_lshlrev_b32 v13, 7, v13
  v_and_b32 v14, 15, v0
  v_lshl_add_u32 v13, v14, 3, v13
  s_mov_b32 s3, 14827520
  s_mov_b32 s4, 0

LF_pollA:
  buffer_load_dwordx2 v[16:17], v13, s[20:23], s3 offen sc1
  s_waitcnt vmcnt(0)
  v_xor_b32 v16, s96, v16
  v_xor_b32 v17, s97, v17
  v_or_b32 v16, v16, v17
  v_cmp_ne_u32 vcc, 0, v16
  s_nop 1
  s_cmp_eq_u64 vcc, 0
  s_cbranch_scc1 LF_polledA
  s_add_u32 s4, s4, 1
  s_cmp_gt_u32 s4, 0x10000
  s_cbranch_scc1 LF_polledA
  s_sleep 4
  s_branch LF_pollA

LF_polledA:
LF_nopollA:
  s_barrier
  buffer_load_dwordx4 v[24:27], v3, s[20:23], s48 offen offset:0 sc1
  buffer_load_dwordx4 v[28:31], v4, s[20:23], s48 offen offset:0 sc1
  buffer_load_dwordx4 v[32:35], v3, s[20:23], s48 offen offset:1024 sc1
  buffer_load_dwordx4 v[36:39], v4, s[20:23], s48 offen offset:1024 sc1
  buffer_load_dwordx4 v[40:43], v3, s[20:23], s48 offen offset:2048 sc1
  buffer_load_dwordx4 v[44:47], v4, s[20:23], s48 offen offset:2048 sc1
  buffer_load_dwordx4 v[48:51], v3, s[20:23], s48 offen offset:3072 sc1
  buffer_load_dwordx4 v[52:55], v4, s[20:23], s48 offen offset:3072 sc1
  buffer_load_dwordx4 v[56:59], v3, s[20:23], s49 offen offset:0 sc1
  buffer_load_dwordx4 v[60:63], v4, s[20:23], s49 offen offset:0 sc1
  buffer_load_dwordx4 v[64:67], v3, s[20:23], s49 offen offset:1024 sc1
  buffer_load_dwordx4 v[68:71], v4, s[20:23], s49 offen offset:1024 sc1
  buffer_load_dwordx4 a[76:79], v11, s[20:23], 0 offen offset:0 sc1
  buffer_load_dwordx4 a[80:83], v11, s[20:23], 0 offen offset:16 sc1
  buffer_load_dwordx4 a[84:87], v11, s[20:23], 0 offen offset:32 sc1
  buffer_load_dwordx4 a[88:91], v11, s[20:23], 0 offen offset:48 sc1
  s_waitcnt vmcnt(16)
  ds_read_b128 v[112:115], v18 offset:0
  ds_read_b128 v[116:119], v18 offset:1024
  ds_read_b128 v[120:123], v18 offset:2048
  ds_read_b128 v[124:127], v18 offset:3072
  s_waitcnt vmcnt(14)
  s_waitcnt lgkmcnt(2)
  v_mfma_f32_32x32x16_bf16 a[0:15], v[24:27], v[112:115], a[0:15]
  v_mfma_f32_32x32x16_bf16 a[16:31], v[24:27], v[116:119], a[16:31]
  v_mfma_f32_32x32x16_bf16 a[32:47], v[28:31], v[112:115], a[32:47]
  v_mfma_f32_32x32x16_bf16 a[48:63], v[28:31], v[116:119], a[48:63]
  buffer_load_dwordx4 v[24:27], v3, s[20:23], s49 offen offset:2048 sc1
  buffer_load_dwordx4 v[28:31], v4, s[20:23], s49 offen offset:2048 sc1
  ds_read_b128 v[112:115], v18 offset:4096
  ds_read_b128 v[116:119], v18 offset:5120
  s_waitcnt vmcnt(14)
  s_waitcnt lgkmcnt(2)
  v_mfma_f32_32x32x16_bf16 a[0:15], v[32:35], v[120:123], a[0:15]
  v_mfma_f32_32x32x16_bf16 a[16:31], v[32:35], v[124:127], a[16:31]
  v_mfma_f32_32x32x16_bf16 a[32:47], v[36:39], v[120:123], a[32:47]
  v_mfma_f32_32x32x16_bf16 a[48:63], v[36:39], v[124:127], a[48:63]
  buffer_load_dwordx4 v[32:35], v3, s[20:23], s49 offen offset:3072 sc1
  buffer_load_dwordx4 v[36:39], v4, s[20:23], s49 offen offset:3072 sc1
  ds_read_b128 v[120:123], v18 offset:6144
  ds_read_b128 v[124:127], v18 offset:7168
  s_waitcnt vmcnt(14)
  s_waitcnt lgkmcnt(2)
  v_mfma_f32_32x32x16_bf16 a[0:15], v[40:43], v[112:115], a[0:15]
  v_mfma_f32_32x32x16_bf16 a[16:31], v[40:43], v[116:119], a[16:31]
  v_mfma_f32_32x32x16_bf16 a[32:47], v[44:47], v[112:115], a[32:47]
  v_mfma_f32_32x32x16_bf16 a[48:63], v[44:47], v[116:119], a[48:63]
  buffer_load_dwordx4 v[40:43], v3, s[20:23], s50 offen offset:0 sc1
  buffer_load_dwordx4 v[44:47], v4, s[20:23], s50 offen offset:0 sc1
  ds_read_b128 v[112:115], v18 offset:8192
  ds_read_b128 v[116:119], v18 offset:9216
  s_waitcnt vmcnt(14)
  s_waitcnt lgkmcnt(2)
  v_mfma_f32_32x32x16_bf16 a[0:15], v[48:51], v[120:123], a[0:15]
  v_mfma_f32_32x32x16_bf16 a[16:31], v[48:51], v[124:127], a[16:31]
  v_mfma_f32_32x32x16_bf16 a[32:47], v[52:55], v[120:123], a[32:47]
  v_mfma_f32_32x32x16_bf16 a[48:63], v[52:55], v[124:127], a[48:63]
  buffer_load_dwordx4 v[48:51], v3, s[20:23], s50 offen offset:1024 sc1
  buffer_load_dwordx4 v[52:55], v4, s[20:23], s50 offen offset:1024 sc1
  ds_read_b128 v[120:123], v18 offset:10240
  ds_read_b128 v[124:127], v18 offset:11264
  s_waitcnt vmcnt(14)
  s_waitcnt lgkmcnt(2)
  v_mfma_f32_32x32x16_bf16 a[0:15], v[56:59], v[112:115], a[0:15]
  v_mfma_f32_32x32x16_bf16 a[16:31], v[56:59], v[116:119], a[16:31]
  v_mfma_f32_32x32x16_bf16 a[32:47], v[60:63], v[112:115], a[32:47]
  v_mfma_f32_32x32x16_bf16 a[48:63], v[60:63], v[116:119], a[48:63]
  buffer_load_dwordx4 v[56:59], v3, s[20:23], s50 offen offset:2048 sc1
  buffer_load_dwordx4 v[60:63], v4, s[20:23], s50 offen offset:2048 sc1
  ds_read_b128 v[112:115], v18 offset:12288
  ds_read_b128 v[116:119], v18 offset:13312
  s_waitcnt vmcnt(14)
  s_waitcnt lgkmcnt(2)
  v_mfma_f32_32x32x16_bf16 a[0:15], v[64:67], v[120:123], a[0:15]
  v_mfma_f32_32x32x16_bf16 a[16:31], v[64:67], v[124:127], a[16:31]
  v_mfma_f32_32x32x16_bf16 a[32:47], v[68:71], v[120:123], a[32:47]
  v_mfma_f32_32x32x16_bf16 a[48:63], v[68:71], v[124:127], a[48:63]
  buffer_load_dwordx4 v[64:67], v3, s[20:23], s50 offen offset:3072 sc1
  buffer_load_dwordx4 v[68:71], v4, s[20:23], s50 offen offset:3072 sc1
  ds_read_b128 v[120:123], v18 offset:14336
  ds_read_b128 v[124:127], v18 offset:15360
  s_waitcnt vmcnt(10)
  s_waitcnt lgkmcnt(2)
  v_mfma_f32_32x32x16_bf16 a[0:15], v[24:27], v[112:115], a[0:15]
  v_mfma_f32_32x32x16_bf16 a[16:31], v[24:27], v[116:119], a[16:31]
  v_mfma_f32_32x32x16_bf16 a[32:47], v[28:31], v[112:115], a[32:47]
  v_mfma_f32_32x32x16_bf16 a[48:63], v[28:31], v[116:119], a[48:63]
  buffer_load_dwordx4 v[24:27], v3, s[20:23], s51 offen offset:0 sc1
  buffer_load_dwordx4 v[28:31], v4, s[20:23], s51 offen offset:0 sc1
  ds_read_b128 v[112:115], v18 offset:16384
  ds_read_b128 v[116:119], v18 offset:17408
  s_waitcnt vmcnt(10)
  s_waitcnt lgkmcnt(2)
  v_mfma_f32_32x32x16_bf16 a[0:15], v[32:35], v[120:123], a[0:15]
  v_mfma_f32_32x32x16_bf16 a[16:31], v[32:35], v[124:127], a[16:31]
  v_mfma_f32_32x32x16_bf16 a[32:47], v[36:39], v[120:123], a[32:47]
  v_mfma_f32_32x32x16_bf16 a[48:63], v[36:39], v[124:127], a[48:63]
  buffer_load_dwordx4 v[32:35], v3, s[20:23], s51 offen offset:1024 sc1
  buffer_load_dwordx4 v[36:39], v4, s[20:23], s51 offen offset:1024 sc1
  s_waitcnt vmcnt(10)
  s_waitcnt lgkmcnt(0)
  v_mfma_f32_32x32x16_bf16 a[0:15], v[40:43], v[112:115], a[0:15]
  v_mfma_f32_32x32x16_bf16 a[16:31], v[40:43], v[116:119], a[16:31]
  v_mfma_f32_32x32x16_bf16 a[32:47], v[44:47], v[112:115], a[32:47]
  v_mfma_f32_32x32x16_bf16 a[48:63], v[44:47], v[116:119], a[48:63]
  buffer_load_dwordx4 v[40:43], v3, s[20:23], s51 offen offset:2048 sc1
  buffer_load_dwordx4 v[44:47], v4, s[20:23], s51 offen offset:2048 sc1
  s_waitcnt vmcnt(10)
  v_mfma_f32_32x32x16_bf16 a[0:15], v[48:51], a[96:99], a[0:15]
  v_mfma_f32_32x32x16_bf16 a[16:31], v[48:51], a[100:103], a[16:31]
  v_mfma_f32_32x32x16_bf16 a[32:47], v[52:55], a[96:99], a[32:47]
  v_mfma_f32_32x32x16_bf16 a[48:63], v[52:55], a[100:103], a[48:63]
  buffer_load_dwordx4 v[48:51], v3, s[20:23], s51 offen offset:3072 sc1
  buffer_load_dwordx4 v[52:55], v4, s[20:23], s51 offen offset:3072 sc1
  s_waitcnt vmcnt(10)
  v_mfma_f32_32x32x16_bf16 a[0:15], v[56:59], a[104:107], a[0:15]
  v_mfma_f32_32x32x16_bf16 a[16:31], v[56:59], a[108:111], a[16:31]
  v_mfma_f32_32x32x16_bf16 a[32:47], v[60:63], a[104:107], a[32:47]
  v_mfma_f32_32x32x16_bf16 a[48:63], v[60:63], a[108:111], a[48:63]
  buffer_load_dwordx4 v[56:59], v3, s[20:23], s52 offen offset:0 sc1
  buffer_load_dwordx4 v[60:63], v4, s[20:23], s52 offen offset:0 sc1
  s_waitcnt vmcnt(10)
  v_mfma_f32_32x32x16_bf16 a[0:15], v[64:67], a[112:115], a[0:15]
  v_mfma_f32_32x32x16_bf16 a[16:31], v[64:67], a[116:119], a[16:31]
  v_mfma_f32_32x32x16_bf16 a[32:47], v[68:71], a[112:115], a[32:47]
  v_mfma_f32_32x32x16_bf16 a[48:63], v[68:71], a[116:119], a[48:63]
  buffer_load_dwordx4 v[64:67], v3, s[20:23], s52 offen offset:1024 sc1
  buffer_load_dwordx4 v[68:71], v4, s[20:23], s52 offen offset:1024 sc1
  s_waitcnt vmcnt(10)
  v_mfma_f32_32x32x16_bf16 a[0:15], v[24:27], a[120:123], a[0:15]
  v_mfma_f32_32x32x16_bf16 a[16:31], v[24:27], a[124:127], a[16:31]
  v_mfma_f32_32x32x16_bf16 a[32:47], v[28:31], a[120:123], a[32:47]
  v_mfma_f32_32x32x16_bf16 a[48:63], v[28:31], a[124:127], a[48:63]
  buffer_load_dwordx4 v[24:27], v3, s[20:23], s52 offen offset:2048 sc1
  buffer_load_dwordx4 v[28:31], v4, s[20:23], s52 offen offset:2048 sc1
  s_waitcnt vmcnt(10)
  v_mfma_f32_32x32x16_bf16 a[0:15], v[32:35], v[72:75], a[0:15]
  v_mfma_f32_32x32x16_bf16 a[16:31], v[32:35], v[76:79], a[16:31]
  v_mfma_f32_32x32x16_bf16 a[32:47], v[36:39], v[72:75], a[32:47]
  v_mfma_f32_32x32x16_bf16 a[48:63], v[36:39], v[76:79], a[48:63]
  buffer_load_dwordx4 v[32:35], v3, s[20:23], s52 offen offset:3072 sc1
  buffer_load_dwordx4 v[36:39], v4, s[20:23], s52 offen offset:3072 sc1
  buffer_load_dwordx4 v[72:75], v5, s[20:23], s52 offen offset:2048 sc1
  buffer_load_dwordx4 v[76:79], v6, s[20:23], s52 offen offset:2048 sc1
  s_waitcnt vmcnt(12)
  v_mfma_f32_32x32x16_bf16 a[0:15], v[40:43], v[80:83], a[0:15]
  v_mfma_f32_32x32x16_bf16 a[16:31], v[40:43], v[84:87], a[16:31]
  v_mfma_f32_32x32x16_bf16 a[32:47], v[44:47], v[80:83], a[32:47]
  v_mfma_f32_32x32x16_bf16 a[48:63], v[44:47], v[84:87], a[48:63]
  buffer_load_dwordx4 v[40:43], v3, s[20:23], s53 offen offset:0 sc1
  buffer_load_dwordx4 v[44:47], v4, s[20:23], s53 offen offset:0 sc1
  buffer_load_dwordx4 v[80:83], v5, s[20:23], s52 offen offset:3072 sc1
  buffer_load_dwordx4 v[84:87], v6, s[20:23], s52 offen offset:3072 sc1
  s_waitcnt vmcnt(14)
  v_mfma_f32_32x32x16_bf16 a[0:15], v[48:51], v[88:91], a[0:15]
  v_mfma_f32_32x32x16_bf16 a[16:31], v[48:51], v[92:95], a[16:31]
  v_mfma_f32_32x32x16_bf16 a[32:47], v[52:55], v[88:91], a[32:47]
  v_mfma_f32_32x32x16_bf16 a[48:63], v[52:55], v[92:95], a[48:63]
  buffer_load_dwordx4 v[48:51], v3, s[20:23], s53 offen offset:1024 sc1
  buffer_load_dwordx4 v[52:55], v4, s[20:23], s53 offen offset:1024 sc1
  buffer_load_dwordx4 v[88:91], v5, s[20:23], s53 offen offset:0 sc1
  buffer_load_dwordx4 v[92:95], v6, s[20:23], s53 offen offset:0 sc1
  s_waitcnt vmcnt(16)
  v_mfma_f32_32x32x16_bf16 a[0:15], v[56:59], v[96:99], a[0:15]
  v_mfma_f32_32x32x16_bf16 a[16:31], v[56:59], v[100:103], a[16:31]
  v_mfma_f32_32x32x16_bf16 a[32:47], v[60:63], v[96:99], a[32:47]
  v_mfma_f32_32x32x16_bf16 a[48:63], v[60:63], v[100:103], a[48:63]
  buffer_load_dwordx4 v[96:99], v5, s[20:23], s53 offen offset:1024 sc1
  buffer_load_dwordx4 v[100:103], v6, s[20:23], s53 offen offset:1024 sc1
  s_waitcnt vmcnt(16)
  v_mfma_f32_32x32x16_bf16 a[0:15], v[64:67], v[104:107], a[0:15]
  v_mfma_f32_32x32x16_bf16 a[16:31], v[64:67], v[108:111], a[16:31]
  v_mfma_f32_32x32x16_bf16 a[32:47], v[68:71], v[104:107], a[32:47]
  v_mfma_f32_32x32x16_bf16 a[48:63], v[68:71], v[108:111], a[48:63]
  s_waitcnt vmcnt(14)
  s_waitcnt vmcnt(10)
  v_mfma_f32_32x32x16_bf16 a[0:15], v[24:27], v[72:75], a[0:15]
  v_mfma_f32_32x32x16_bf16 a[16:31], v[24:27], v[76:79], a[16:31]
  v_mfma_f32_32x32x16_bf16 a[32:47], v[28:31], v[72:75], a[32:47]
  v_mfma_f32_32x32x16_bf16 a[48:63], v[28:31], v[76:79], a[48:63]
  s_waitcnt vmcnt(6)
  v_mfma_f32_32x32x16_bf16 a[0:15], v[32:35], v[80:83], a[0:15]
  v_mfma_f32_32x32x16_bf16 a[16:31], v[32:35], v[84:87], a[16:31]
  v_mfma_f32_32x32x16_bf16 a[32:47], v[36:39], v[80:83], a[32:47]
  v_mfma_f32_32x32x16_bf16 a[48:63], v[36:39], v[84:87], a[48:63]
  s_waitcnt vmcnt(2)
  v_mfma_f32_32x32x16_bf16 a[0:15], v[40:43], v[88:91], a[0:15]
  v_mfma_f32_32x32x16_bf16 a[16:31], v[40:43], v[92:95], a[16:31]
  v_mfma_f32_32x32x16_bf16 a[32:47], v[44:47], v[88:91], a[32:47]
  v_mfma_f32_32x32x16_bf16 a[48:63], v[44:47], v[92:95], a[48:63]
  s_waitcnt vmcnt(0)
  v_mfma_f32_32x32x16_bf16 a[0:15], v[48:51], v[96:99], a[0:15]
  v_mfma_f32_32x32x16_bf16 a[16:31], v[48:51], v[100:103], a[16:31]
  v_mfma_f32_32x32x16_bf16 a[32:47], v[52:55], v[96:99], a[32:47]
  v_mfma_f32_32x32x16_bf16 a[48:63], v[52:55], v[100:103], a[48:63]
  s_nop 15
  ds_write_b128 v18, a[0:3] offset:0
  ds_write_b128 v18, a[4:7] offset:1024
  ds_write_b128 v18, a[8:11] offset:2048
  ds_write_b128 v18, a[12:15] offset:3072
  ds_write_b128 v18, a[16:19] offset:4096
  ds_write_b128 v18, a[20:23] offset:5120
  ds_write_b128 v18, a[24:27] offset:6144
  ds_write_b128 v18, a[28:31] offset:7168
  ds_write_b128 v18, a[32:35] offset:8192
  ds_write_b128 v18, a[36:39] offset:9216
  ds_write_b128 v18, a[40:43] offset:10240
  ds_write_b128 v18, a[44:47] offset:11264
  ds_write_b128 v18, a[48:51] offset:12288
  ds_write_b128 v18, a[52:55] offset:13312
  ds_write_b128 v18, a[56:59] offset:14336
  ds_write_b128 v18, a[60:63] offset:15360
  v_accvgpr_read_b32 v104, a64
  v_accvgpr_read_b32 v105, a65
  v_accvgpr_read_b32 v106, a66
  v_accvgpr_read_b32 v107, a67
  v_accvgpr_read_b32 v108, a68
  v_accvgpr_read_b32 v109, a69
  v_accvgpr_read_b32 v110, a70
  v_accvgpr_read_b32 v111, a71
  v_accvgpr_read_b32 v72, a76
  v_accvgpr_read_b32 v73, a77
  v_accvgpr_read_b32 v74, a78
  v_accvgpr_read_b32 v75, a79
  v_accvgpr_read_b32 v76, a80
  v_accvgpr_read_b32 v77, a81
  v_accvgpr_read_b32 v78, a82
  v_accvgpr_read_b32 v79, a83
  v_accvgpr_read_b32 v80, a84
  v_accvgpr_read_b32 v81, a85
  v_accvgpr_read_b32 v82, a86
  v_accvgpr_read_b32 v83, a87
  v_accvgpr_read_b32 v84, a88
  v_accvgpr_read_b32 v85, a89
  v_accvgpr_read_b32 v86, a90
  v_accvgpr_read_b32 v87, a91
  v_accvgpr_read_b32 v13, a72
  v_lshlrev_b32 v13, 16, v13
  v_lshlrev_b32 v104, 16, v104
  v_lshlrev_b32 v105, 16, v105
  v_lshlrev_b32 v106, 16, v106
  v_lshlrev_b32 v107, 16, v107
  v_lshlrev_b32 v108, 16, v108
  v_lshlrev_b32 v109, 16, v109
  v_lshlrev_b32 v110, 16, v110
  v_lshlrev_b32 v111, 16, v111
  v_sub_f32 v112, v104, v72
  v_sub_f32 v113, v105, v74
  v_cvt_pk_bf16_f32 v120, v112, v113
  v_lshlrev_b32 v112, 16, v120
  v_and_b32 v113, 0xffff0000, v120
  v_mul_f32 v112, v112, v73
  v_mul_f32 v113, v113, v75
  v_cvt_pk_bf16_f32 v120, v112, v113
  v_lshlrev_b32 v112, 16, v120
  v_and_b32 v113, 0xffff0000, v120
  v_mul_f32 v112, v112, v13
  v_mul_f32 v113, v113, v13
  v_cvt_pk_bf16_f32 v120, v112, v113
  v_lshlrev_b32 v112, 16, v120
  v_and_b32 v113, 0xffff0000, v120
  v_add_f32 v96, v112, v104
  v_add_f32 v97, v113, v105

  v_sub_f32 v116, v106, v76
  v_sub_f32 v117, v107, v78
  v_cvt_pk_bf16_f32 v121, v116, v117
  v_lshlrev_b32 v116, 16, v121
  v_and_b32 v117, 0xffff0000, v121
  v_mul_f32 v116, v116, v77
  v_mul_f32 v117, v117, v79
  v_cvt_pk_bf16_f32 v121, v116, v117
  v_lshlrev_b32 v116, 16, v121
  v_and_b32 v117, 0xffff0000, v121
  v_mul_f32 v116, v116, v13
  v_mul_f32 v117, v117, v13
  v_cvt_pk_bf16_f32 v121, v116, v117
  v_lshlrev_b32 v116, 16, v121
  v_and_b32 v117, 0xffff0000, v121
  v_add_f32 v98, v116, v106
  v_add_f32 v99, v117, v107

  v_sub_f32 v112, v108, v80
  v_sub_f32 v113, v109, v82
  v_cvt_pk_bf16_f32 v120, v112, v113
  v_lshlrev_b32 v112, 16, v120
  v_and_b32 v113, 0xffff0000, v120
  v_mul_f32 v112, v112, v81
  v_mul_f32 v113, v113, v83
  v_cvt_pk_bf16_f32 v120, v112, v113
  v_lshlrev_b32 v112, 16, v120
  v_and_b32 v113, 0xffff0000, v120
  v_mul_f32 v112, v112, v13
  v_mul_f32 v113, v113, v13
  v_cvt_pk_bf16_f32 v120, v112, v113
  v_lshlrev_b32 v112, 16, v120
  v_and_b32 v113, 0xffff0000, v120
  v_add_f32 v100, v112, v108
  v_add_f32 v101, v113, v109

  v_sub_f32 v116, v110, v84
  v_sub_f32 v117, v111, v86
  v_cvt_pk_bf16_f32 v121, v116, v117
  v_lshlrev_b32 v116, 16, v121
  v_and_b32 v117, 0xffff0000, v121
  v_mul_f32 v116, v116, v85
  v_mul_f32 v117, v117, v87
  v_cvt_pk_bf16_f32 v121, v116, v117
  v_lshlrev_b32 v116, 16, v121
  v_and_b32 v117, 0xffff0000, v121
  v_mul_f32 v116, v116, v13
  v_mul_f32 v117, v117, v13
  v_cvt_pk_bf16_f32 v121, v116, v117
  v_lshlrev_b32 v116, 16, v121
  v_and_b32 v117, 0xffff0000, v121
  v_add_f32 v102, v116, v110
  v_add_f32 v103, v117, v111

  s_mov_b32 s56, 0
  s_mov_b32 s57, 4096
  s_mov_b32 s58, 8192
  s_mov_b32 s59, 12288
  s_lshl_b32 s35, s44, 11
  v_lshlrev_b32 v15, 4, v0
  v_add_u32 v15, s35, v15
  v_add_u32 v14, 73728, v15
  s_waitcnt lgkmcnt(0)
  s_barrier

  ds_read_b128 v[24:27], v15 offset:0
  ds_read_b128 v[28:31], v15 offset:1024
  ds_read_b128 v[32:35], v15 offset:18432
  ds_read_b128 v[36:39], v15 offset:19456
  ds_read_b128 v[40:43], v15 offset:36864
  ds_read_b128 v[44:47], v15 offset:37888
  ds_read_b128 v[48:51], v15 offset:55296
  ds_read_b128 v[52:55], v15 offset:56320
  ds_read_b128 v[56:59], v14 offset:0
  ds_read_b128 v[60:63], v14 offset:1024
  ds_read_b128 v[64:67], v14 offset:18432
  ds_read_b128 v[68:71], v14 offset:19456
  ds_read_b128 v[72:75], v14 offset:36864
  ds_read_b128 v[76:79], v14 offset:37888
  ds_read_b128 v[80:83], v14 offset:55296
  ds_read_b128 v[84:87], v14 offset:56320
  s_waitcnt lgkmcnt(8)
  v_add_f32 v24, v24, v32
  v_add_f32 v40, v40, v48
  v_add_f32 v25, v25, v33
  v_add_f32 v41, v41, v49
  v_add_f32 v26, v26, v34
  v_add_f32 v42, v42, v50
  v_add_f32 v27, v27, v35
  v_add_f32 v43, v43, v51
  v_add_f32 v28, v28, v36
  v_add_f32 v44, v44, v52
  v_add_f32 v29, v29, v37
  v_add_f32 v45, v45, v53
  v_add_f32 v30, v30, v38
  v_add_f32 v46, v46, v54
  v_add_f32 v31, v31, v39
  v_add_f32 v47, v47, v55
  v_add_f32 v96, v96, v24
  v_add_f32 v96, v96, v40
  v_add_f32 v97, v97, v25
  v_add_f32 v97, v97, v41
  v_add_f32 v98, v98, v26
  v_add_f32 v98, v98, v42
  v_add_f32 v99, v99, v27
  v_add_f32 v99, v99, v43
  v_add_f32 v100, v100, v28
  v_add_f32 v100, v100, v44
  v_add_f32 v101, v101, v29
  v_add_f32 v101, v101, v45
  v_add_f32 v102, v102, v30
  v_add_f32 v102, v102, v46
  v_add_f32 v103, v103, v31
  v_add_f32 v103, v103, v47
  s_waitcnt lgkmcnt(0)
  v_add_f32 v56, v56, v64
  v_add_f32 v72, v72, v80
  v_add_f32 v57, v57, v65
  v_add_f32 v73, v73, v81
  v_add_f32 v58, v58, v66
  v_add_f32 v74, v74, v82
  v_add_f32 v59, v59, v67
  v_add_f32 v75, v75, v83
  v_add_f32 v60, v60, v68
  v_add_f32 v76, v76, v84
  v_add_f32 v61, v61, v69
  v_add_f32 v77, v77, v85
  v_add_f32 v62, v62, v70
  v_add_f32 v78, v78, v86
  v_add_f32 v63, v63, v71
  v_add_f32 v79, v79, v87
  v_add_f32 v96, v96, v56
  v_add_f32 v96, v96, v72
  v_add_f32 v97, v97, v57
  v_add_f32 v97, v97, v73
  v_add_f32 v98, v98, v58
  v_add_f32 v98, v98, v74
  v_add_f32 v99, v99, v59
  v_add_f32 v99, v99, v75
  v_add_f32 v100, v100, v60
  v_add_f32 v100, v100, v76
  v_add_f32 v101, v101, v61
  v_add_f32 v101, v101, v77
  v_add_f32 v102, v102, v62
  v_add_f32 v102, v102, v78
  v_add_f32 v103, v103, v63
  v_add_f32 v103, v103, v79
  buffer_store_dword v96, v10, s[16:19], s56 offen offset:0
  buffer_store_dword v97, v10, s[16:19], s56 offen offset:2048
  buffer_store_dword v98, v10, s[16:19], s57 offen offset:0
  buffer_store_dword v99, v10, s[16:19], s57 offen offset:2048
  buffer_store_dword v100, v10, s[16:19], s58 offen offset:0
  buffer_store_dword v101, v10, s[16:19], s58 offen offset:2048
  buffer_store_dword v102, v10, s[16:19], s59 offen offset:0
  buffer_store_dword v103, v10, s[16:19], s59 offen offset:2048
LB_done:
  s_endpgm

.section .rodata,"a"
.p2align 6
.amdhsa_kernel phase_b_kernel
  .amdhsa_next_free_vgpr 256
  .amdhsa_next_free_sgpr 102
  .amdhsa_accum_offset 128
  .amdhsa_group_segment_fixed_size 0
  .amdhsa_kernarg_size 128
  .amdhsa_user_sgpr_count 2
  .amdhsa_user_sgpr_kernarg_segment_ptr 1
  .amdhsa_system_sgpr_workgroup_id_x 1
  .amdhsa_float_denorm_mode_32 3
.end_amdhsa_kernel
```
